```python
import torch

def _softmax(x, axis=-1):
    return torch.softmax(x, dim=axis)
def _gelu(x):
    return torch.nn.functional.gelu(x, approximate="tanh")
def _silu(x):
    return torch.nn.functional.silu(x)
def _sigmoid(x):
    return torch.sigmoid(x)
def _layernorm(x, axis=-1, eps=1e-5):
    m = x.mean(dim=axis, keepdim=True)
    v = x.var(dim=axis, keepdim=True, unbiased=False)
    return (x - m) / torch.sqrt(v + eps)
def _scatter_add(tgt, idx, src, axis=0):
    return tgt.clone().index_add_(axis, idx, src)
def _segment_sum(src, seg, n):
    out = torch.zeros((n,) + src.shape[1:], dtype=src.dtype)
    return out.index_add_(0, seg, src)
def _pad(x, pw):
    flat = tuple(v for pair in reversed(pw) for v in pair)
    return torch.nn.functional.pad(x, flat)

kernel_name = 'concat_heads__softmax_full_mha__linear_kernel_hedgehog__prompt'

def setup_inputs():

    _w = (lambda a: (lambda t: t.to(torch.bfloat16) if t.is_floating_point() else t)(torch.as_tensor(a)))
    def _A_setup():
        B, S, D = 1, 2048, 640
        return {
            "x": _w((lambda *s: torch.randn(*s, dtype=torch.bfloat16) * 0.2)(B, S, D)),
            "wqkv": _w((lambda *s: torch.randn(*s, dtype=torch.bfloat16) * 0.2)(D, 3 * D)),
            "wo": _w((lambda *s: torch.randn(*s, dtype=torch.bfloat16) * 0.05)(D, D)),
        }
    _A_in = _A_setup()

    def _B_setup():
        B, S, D, H = 1, 2048, 640, 32
        Dh = D // H
        return {
            "x": _w((lambda *s: torch.randn(*s, dtype=torch.bfloat16) * 0.4)(B, S, D)),
            "wqkv": _w((lambda *s: torch.randn(*s, dtype=torch.bfloat16) * 0.4)(D, 3 * D)),
            "w_phi": _w((lambda *s: torch.randn(*s, dtype=torch.bfloat16) * 0.4)(H, Dh, Dh) * (Dh ** -0.5)),
            "wo": _w((lambda *s: torch.randn(*s, dtype=torch.bfloat16) * 0.05)(D, D)),
        }
    _B_in = _B_setup()

    return {
        "A_x": _A_in["x"],
        "A_wqkv": _A_in["wqkv"],
        "A_wo": _A_in["wo"],
        "B_x": _B_in["x"],
        "B_wqkv": _B_in["wqkv"],
        "B_w_phi": _B_in["w_phi"],
        "B_wo": _B_in["wo"],
    }

def reference(A_x, A_wqkv, A_wo, B_x, B_wqkv, B_w_phi, B_wo):
    def _A_ref(x, wqkv, wo):
        B, S, D = x.shape
        H = 32; Dh = D // H
        qkv = (lambda x, *d: x.permute(*d))((x @ wqkv).reshape(B, S, 3, H, Dh), 2, 0, 3, 1, 4)
        q, k, v = qkv[0], qkv[1], qkv[2]
        scale = Dh ** -0.5
        scores = torch.einsum("bhqd,bhkd->bhqk", q, k) * scale
        p = _softmax(scores, axis=-1)
        o = torch.einsum("bhqk,bhkd->bhqd", p, v)
        return (lambda x, *d: x.permute(*d))(o, 0, 2, 1, 3).reshape(B, S, D) @ wo

    def _B_ref(x, wqkv, w_phi, wo):
        B, S, D = x.shape
        H = 32; Dh = D // H
        qkv = (lambda x, *d: x.permute(*d))((x @ wqkv).reshape(B, S, 3, H, Dh), 2, 0, 3, 1, 4)
        q, k, v = qkv[0], qkv[1], qkv[2]
        pq = torch.einsum("bhsd,hdf->bhsf", q, w_phi)
        pk = torch.einsum("bhsd,hdf->bhsf", k, w_phi)
        phi_q = torch.concatenate([_softmax(pq, axis=-1), _softmax(-pq, axis=-1)], axis=-1)
        phi_k = torch.concatenate([_softmax(pk, axis=-1), _softmax(-pk, axis=-1)], axis=-1)
        kv = torch.einsum("bhsf,bhsd->bhfd", phi_k, v)
        z  = torch.einsum("bhsf->bhf", phi_k)
        num = torch.einsum("bhqf,bhfd->bhqd", phi_q, kv)
        den = torch.einsum("bhqf,bhf->bhq", phi_q, z)[..., None] + 1e-6
        o = num / den
        return (lambda x, *d: x.permute(*d))(o, 0, 2, 1, 3).reshape(B, S, D) @ wo

    a = _A_ref(A_x, A_wqkv, A_wo)
    b = _B_ref(B_x, B_wqkv, B_w_phi, B_wo)
    return torch.concatenate([a, b], axis=-1)
```

```asm
; @launch kernel=k1_kernel grid=(256,1,1) block=(512,1,1) lds=154624
; @launch kernel=k2_kernel grid=(256,1,1) block=(512,1,1) lds=163840
.amdgcn_target "amdgcn-amd-amdhsa--gfx950"
.text
.globl k1_kernel
.p2align 8
.type k1_kernel,@function
k1_kernel:
  s_cmp_ge_u32 s2, 256
  s_cbranch_scc1 k1_kernel_end
  s_load_dwordx4 s[4:7], s[0:1], 0
  s_load_dwordx4 s[8:11], s[0:1], 24
  s_load_dwordx2 s[12:13], s[0:1], 72
  v_and_b32 v1, 63, v0
  v_lshrrev_b32 v2, 6, v0
  s_and_b32 s14, s2, 7
  s_lshr_b32 s15, s2, 3
  v_readfirstlane_b32 s20, v2
  s_lshr_b32 s21, s14, 2
  s_bfe_u32 s16, s14, 0x10001
  s_lshl_b32 s16, s16, 3
  s_and_b32 s17, s15, 7
  s_add_u32 s22, s16, s17
  s_and_b32 s16, s14, 1
  s_lshl_b32 s16, s16, 2
  s_lshr_b32 s17, s15, 3
  s_add_u32 s23, s16, s17
  s_cmp_ge_u32 s20, 4
  s_cbranch_scc1 k1_kernel_loader
  s_and_b32 s24, s20, 1
  s_lshr_b32 s25, s20, 1
  s_waitcnt lgkmcnt(0)
  s_mov_b32 s36, s12
  s_mov_b32 s37, s13
  s_mov_b32 s38, 0x10000000
  s_mov_b32 s39, 0x00020000
  v_and_b32 v2, 15, v1
  v_lshrrev_b32 v3, 4, v1
  v_and_b32 v4, 7, v2
  v_xor_b32 v4, v4, v3
  v_lshlrev_b32 v4, 4, v4
  v_lshl_add_u32 v4, v2, 7, v4
  s_lshl_b32 s16, s24, 13
  s_lshl_b32 s17, s25, 12
  s_add_u32 s18, s16, s17
  v_add_u32 v16, s18, v4
  s_xor_b32 s17, s17, 4096
  s_add_u32 s18, s16, s17
  v_add_u32 v18, s18, v4
  v_xor_b32 v17, 64, v16
  v_xor_b32 v19, 64, v18
  v_lshrrev_b32 v4, 1, v3
  v_lshlrev_b32 v4, 3, v4
  v_and_b32 v5, 1, v3
  v_lshl_add_u32 v4, v5, 1, v4
  v_lshrrev_b32 v5, 3, v2
  v_add_u32 v4, v4, v5
  v_mul_u32_u24 v4, 1088, v4
  v_bfe_u32 v5, v2, 2, 1
  v_mul_u32_u24 v5, 480, v5
  v_add_u32 v4, v4, v5
  v_and_b32 v5, 3, v2
  v_lshl_add_u32 v4, v5, 3, v4
  v_add_u32 v21, 49152, v4
  s_mul_i32 s16, s25, 96
  v_add_u32 v20, s16, v21
  s_lshl_b32 s16, s24, 6
  s_lshl_b32 s17, s25, 5
  s_xor_b32 s18, s17, 0
  s_add_u32 s18, s18, s16
  v_add_u32 v28, s18, v2
  s_xor_b32 s18, s17, 16
  s_add_u32 s18, s18, s16
  v_add_u32 v29, s18, v2
  s_xor_b32 s18, s17, 32
  s_add_u32 s18, s18, s16
  v_add_u32 v30, s18, v2
  s_xor_b32 s18, s17, 48
  s_add_u32 s18, s18, s16
  v_add_u32 v31, s18, v2
  s_mul_i32 s18, s25, 12
  s_add_u32 s18, s18, 0
  v_add_u32 v4, s18, v3
  v_mul_u32_u24 v5, 13, v4
  v_lshrrev_b32 v5, 6, v5
  v_mul_u32_u24 v6, 5, v5
  v_sub_u32 v6, v4, v6
  v_mul_u32_u24 v5, 5120, v5
  v_lshrrev_b32 v7, 1, v6
  v_lshlrev_b32 v7, 11, v7
  v_and_b32 v40, 1, v6
  v_lshl_add_u32 v7, v40, 3, v7
  v_add_u32 v22, v5, v7
  v_cmp_eq_u32 vcc, 4, v6
  v_mov_b32 v41, 16
  s_lshl_b32 s19, s18, 2
  v_cndmask_b32 v25, v41, 8, vcc
  v_add_u32 v4, s19, v2
  v_mul_u32_u24 v5, 205, v4
  v_lshrrev_b32 v5, 12, v5
  v_mul_u32_u24 v6, 20, v5
  v_sub_u32 v6, v4, v6
  v_mul_u32_u24 v5, 5120, v5
  v_lshl_add_u32 v5, v6, 4, v5
  v_lshrrev_b32 v7, 1, v3
  v_mul_u32_u24 v7, 320, v7
  v_and_b32 v40, 1, v3
  v_lshl_add_u32 v7, v40, 3, v7
  s_mul_i32 s19, s24, 2560
  v_add3_u32 v5, v5, v7, s19
  s_mul_i32 s19, s25, 1280
  v_add_u32 v32, s19, v5
  s_sub_u32 s19, 1280, s19
  v_add_u32 v33, s19, v5
  s_mul_i32 s18, s25, 12
  s_add_u32 s18, s18, 4
  v_add_u32 v4, s18, v3
  v_mul_u32_u24 v5, 13, v4
  v_lshrrev_b32 v5, 6, v5
  v_mul_u32_u24 v6, 5, v5
  v_sub_u32 v6, v4, v6
  v_mul_u32_u24 v5, 5120, v5
  v_lshrrev_b32 v7, 1, v6
  v_lshlrev_b32 v7, 11, v7
  v_and_b32 v40, 1, v6
  v_lshl_add_u32 v7, v40, 3, v7
  v_add_u32 v23, v5, v7
  v_cmp_eq_u32 vcc, 4, v6
  v_mov_b32 v41, 16
  s_lshl_b32 s19, s18, 2
  v_cndmask_b32 v26, v41, 8, vcc
  v_add_u32 v4, s19, v2
  v_mul_u32_u24 v5, 205, v4
  v_lshrrev_b32 v5, 12, v5
  v_mul_u32_u24 v6, 20, v5
  v_sub_u32 v6, v4, v6
  v_mul_u32_u24 v5, 5120, v5
  v_lshl_add_u32 v5, v6, 4, v5
  v_lshrrev_b32 v7, 1, v3
  v_mul_u32_u24 v7, 320, v7
  v_and_b32 v40, 1, v3
  v_lshl_add_u32 v7, v40, 3, v7
  s_mul_i32 s19, s24, 2560
  v_add3_u32 v5, v5, v7, s19
  s_mul_i32 s19, s25, 1280
  v_add_u32 v34, s19, v5
  s_sub_u32 s19, 1280, s19
  v_add_u32 v35, s19, v5
  s_mov_b32 s18, 8
  v_add_u32 v4, s18, v3
  v_mul_u32_u24 v5, 13, v4
  v_lshrrev_b32 v5, 6, v5
  v_mul_u32_u24 v6, 5, v5
  v_sub_u32 v6, v4, v6
  v_mul_u32_u24 v5, 5120, v5
  v_lshrrev_b32 v7, 1, v6
  v_lshlrev_b32 v7, 11, v7
  v_and_b32 v40, 1, v6
  v_lshl_add_u32 v7, v40, 3, v7
  v_add_u32 v24, v5, v7
  v_cmp_eq_u32 vcc, 4, v6
  v_mov_b32 v41, 16
  s_lshl_b32 s19, s18, 2
  v_cndmask_b32 v27, v41, 8, vcc
  v_add_u32 v4, s19, v2
  v_mul_u32_u24 v5, 205, v4
  v_lshrrev_b32 v5, 12, v5
  v_mul_u32_u24 v6, 20, v5
  v_sub_u32 v6, v4, v6
  v_mul_u32_u24 v5, 5120, v5
  v_lshl_add_u32 v5, v6, 4, v5
  v_lshrrev_b32 v7, 1, v3
  v_mul_u32_u24 v7, 320, v7
  v_and_b32 v40, 1, v3
  v_lshl_add_u32 v7, v40, 3, v7
  s_mul_i32 s19, s24, 2560
  v_add3_u32 v5, v5, v7, s19
  s_mul_i32 s19, s25, 1280
  v_add_u32 v36, s19, v5
  s_sub_u32 s19, 1280, s19
  v_add_u32 v37, s19, v5
  s_mul_i32 s18, s23, 3
  s_add_u32 s18, s18, 0
  s_lshr_b32 s18, s18, 3
  s_add_u32 s18, s18, s21
  s_cmp_eq_u32 s18, 0
  s_cselect_b32 s56, 0x3ea52b5c, 1.0
  s_mov_b32 s57, s56
  s_mul_i32 s18, s23, 3
  s_add_u32 s18, s18, 1
  s_lshr_b32 s18, s18, 3
  s_add_u32 s18, s18, s21
  s_cmp_eq_u32 s18, 0
  s_cselect_b32 s58, 0x3ea52b5c, 1.0
  s_mov_b32 s59, s58
  s_mul_i32 s18, s23, 3
  s_add_u32 s18, s18, 2
  s_lshr_b32 s18, s18, 3
  s_add_u32 s18, s18, s21
  s_cmp_eq_u32 s18, 0
  s_cselect_b32 s60, 0x3ea52b5c, 1.0
  s_mov_b32 s61, s60
  v_mov_b32 v40, 0
  v_mov_b32 v41, 0
  v_mov_b32 v42, 0
  v_mov_b32 v43, 0
  v_mov_b32 v44, 0
  v_mov_b32 v45, 0
  v_mov_b32 v46, 0
  v_mov_b32 v47, 0
  v_mov_b32 v48, 0
  v_mov_b32 v49, 0
  v_mov_b32 v50, 0
  v_mov_b32 v51, 0
  v_mov_b32 v52, 0
  v_mov_b32 v53, 0
  v_mov_b32 v54, 0
  v_mov_b32 v55, 0
  v_mov_b32 v56, 0
  v_mov_b32 v57, 0
  v_mov_b32 v58, 0
  v_mov_b32 v59, 0
  v_mov_b32 v60, 0
  v_mov_b32 v61, 0
  v_mov_b32 v62, 0
  v_mov_b32 v63, 0
  v_mov_b32 v64, 0
  v_mov_b32 v65, 0
  v_mov_b32 v66, 0
  v_mov_b32 v67, 0
  v_mov_b32 v68, 0
  v_mov_b32 v69, 0
  v_mov_b32 v70, 0
  v_mov_b32 v71, 0
  v_mov_b32 v72, 0
  v_mov_b32 v73, 0
  v_mov_b32 v74, 0
  v_mov_b32 v75, 0
  v_mov_b32 v76, 0
  v_mov_b32 v77, 0
  v_mov_b32 v78, 0
  v_mov_b32 v79, 0
  v_mov_b32 v80, 0
  v_mov_b32 v81, 0
  v_mov_b32 v82, 0
  v_mov_b32 v83, 0
  v_mov_b32 v84, 0
  v_mov_b32 v85, 0
  v_mov_b32 v86, 0
  v_mov_b32 v87, 0
  v_mov_b32 v88, 0
  v_mov_b32 v89, 0
  v_mov_b32 v90, 0
  v_mov_b32 v91, 0
  v_mov_b32 v92, 0
  v_mov_b32 v93, 0
  v_mov_b32 v94, 0
  v_mov_b32 v95, 0
  v_mov_b32 v96, 0
  v_mov_b32 v97, 0
  v_mov_b32 v98, 0
  v_mov_b32 v99, 0
  v_mov_b32 v100, 0
  v_mov_b32 v101, 0
  v_mov_b32 v102, 0
  v_mov_b32 v103, 0
  v_mov_b32 v104, 0
  v_mov_b32 v105, 0
  v_mov_b32 v106, 0
  v_mov_b32 v107, 0
  v_mov_b32 v108, 0
  v_mov_b32 v109, 0
  v_mov_b32 v110, 0
  v_mov_b32 v111, 0
  v_mov_b32 v112, 0
  v_mov_b32 v113, 0
  v_mov_b32 v114, 0
  v_mov_b32 v115, 0
  v_mov_b32 v116, 0
  v_mov_b32 v117, 0
  v_mov_b32 v118, 0
  v_mov_b32 v119, 0
  v_mov_b32 v120, 0
  v_mov_b32 v121, 0
  v_mov_b32 v122, 0
  v_mov_b32 v123, 0
  v_mov_b32 v124, 0
  v_mov_b32 v125, 0
  v_mov_b32 v126, 0
  v_mov_b32 v127, 0
  v_mov_b32 v128, 0
  v_mov_b32 v129, 0
  v_mov_b32 v130, 0
  v_mov_b32 v131, 0
  v_mov_b32 v132, 0
  v_mov_b32 v133, 0
  v_mov_b32 v134, 0
  v_mov_b32 v135, 0
  v_mov_b32 v136, 0
  v_mov_b32 v137, 0
  v_mov_b32 v138, 0
  v_mov_b32 v139, 0
  v_mov_b32 v140, 0
  v_mov_b32 v141, 0
  v_mov_b32 v142, 0
  v_mov_b32 v143, 0
  v_mov_b32 v144, 0
  v_mov_b32 v145, 0
  v_mov_b32 v146, 0
  v_mov_b32 v147, 0
  v_mov_b32 v148, 0
  v_mov_b32 v149, 0
  v_mov_b32 v150, 0
  v_mov_b32 v151, 0
  v_mov_b32 v152, 0
  v_mov_b32 v153, 0
  v_mov_b32 v154, 0
  v_mov_b32 v155, 0
  v_mov_b32 v156, 0
  v_mov_b32 v157, 0
  v_mov_b32 v158, 0
  v_mov_b32 v159, 0
  v_mov_b32 v160, 0
  v_mov_b32 v161, 0
  v_mov_b32 v162, 0
  v_mov_b32 v163, 0
  v_mov_b32 v164, 0
  v_mov_b32 v165, 0
  v_mov_b32 v166, 0
  v_mov_b32 v167, 0
  v_mov_b32 v168, 0
  v_mov_b32 v169, 0
  v_mov_b32 v170, 0
  v_mov_b32 v171, 0
  v_mov_b32 v172, 0
  v_mov_b32 v173, 0
  v_mov_b32 v174, 0
  v_mov_b32 v175, 0
  v_mov_b32 v176, 0
  v_mov_b32 v177, 0
  v_mov_b32 v178, 0
  v_mov_b32 v179, 0
  v_mov_b32 v180, 0
  v_mov_b32 v181, 0
  v_mov_b32 v182, 0
  v_mov_b32 v183, 0
  v_mov_b32 v184, 0
  v_mov_b32 v185, 0
  v_mov_b32 v186, 0
  v_mov_b32 v187, 0
  v_mov_b32 v188, 0
  v_mov_b32 v189, 0
  v_mov_b32 v190, 0
  v_mov_b32 v191, 0
  v_mov_b32 v192, 0
  v_mov_b32 v193, 0
  v_mov_b32 v194, 0
  v_mov_b32 v195, 0
  v_mov_b32 v196, 0
  v_mov_b32 v197, 0
  v_mov_b32 v198, 0
  v_mov_b32 v199, 0
  v_mov_b32 v200, 0
  v_mov_b32 v201, 0
  v_mov_b32 v202, 0
  v_mov_b32 v203, 0
  v_mov_b32 v204, 0
  v_mov_b32 v205, 0
  v_mov_b32 v206, 0
  v_mov_b32 v207, 0
  v_mov_b32 v208, 0
  v_mov_b32 v209, 0
  v_mov_b32 v210, 0
  v_mov_b32 v211, 0
  v_mov_b32 v212, 0
  v_mov_b32 v213, 0
  v_mov_b32 v214, 0
  v_mov_b32 v215, 0
  s_mov_b32 s42, 0
  s_mov_b32 s43, 0
  s_mov_b32 s50, 2621440
  s_mov_b32 s51, 2457600
  s_mov_b32 s52, 16384
  s_mov_b32 s53, 4294934528
  s_mov_b32 s54, 34816
  s_mov_b32 s55, 4294897664
  s_barrier
  s_cmp_ge_u32 s23, 6
  s_cbranch_scc1 k1_kernel_vd
  s_cmp_eq_u32 s23, 5
  s_cbranch_scc1 k1_kernel_vm
.p2align 6
k1_kernel_loop_t:
  ds_read_b128 v[40:43], v16 offset:0
  ds_read_b128 v[44:47], v16 offset:2048
  v_mfma_f32_16x16x32_bf16 v[200:203], v[80:83], v[56:59], v[200:203]
  ds_read_b128 v[48:51], v18 offset:0
  ds_read_b128 v[52:55], v18 offset:2048
  v_mfma_f32_16x16x32_bf16 v[204:207], v[80:83], v[60:63], v[204:207]
  ds_read_b64_tr_b16 v[72:73], v20 offset:0
  ds_read_b64_tr_b16 v[74:75], v20 offset:4352
  v_mfma_f32_16x16x32_bf16 v[160:163], v[84:87], v[56:59], v[160:163]
  ds_read_b64_tr_b16 v[76:77], v20 offset:32
  ds_read_b64_tr_b16 v[78:79], v20 offset:4384
  v_mfma_f32_16x16x32_bf16 v[164:167], v[84:87], v[60:63], v[164:167]
  ds_read_b64_tr_b16 v[80:81], v21 offset:64
  ds_read_b64_tr_b16 v[82:83], v21 offset:4416
  v_mfma_f32_16x16x32_bf16 v[168:171], v[84:87], v[64:67], v[168:171]
  v_mfma_f32_16x16x32_bf16 v[172:175], v[84:87], v[68:71], v[172:175]
  v_mfma_f32_16x16x32_bf16 v[176:179], v[88:91], v[56:59], v[176:179]
  v_mfma_f32_16x16x32_bf16 v[180:183], v[88:91], v[60:63], v[180:183]
  v_mfma_f32_16x16x32_bf16 v[184:187], v[88:91], v[64:67], v[184:187]
  v_mfma_f32_16x16x32_bf16 v[188:191], v[88:91], v[68:71], v[188:191]
  v_mfma_f32_16x16x32_bf16 v[208:211], v[92:95], v[56:59], v[208:211]
  v_mfma_f32_16x16x32_bf16 v[212:215], v[92:95], v[60:63], v[212:215]
  ds_read_b128 v[56:59], v17 offset:0
  s_waitcnt lgkmcnt(5)
  v_mfma_f32_16x16x32_bf16 v[96:99], v[72:75], v[40:43], v[96:99]
  ds_read_b128 v[60:63], v17 offset:2048
  ds_read_b128 v[64:67], v19 offset:0
  v_mfma_f32_16x16x32_bf16 v[100:103], v[72:75], v[44:47], v[100:103]
  ds_read_b128 v[68:71], v19 offset:2048
  ds_read_b64_tr_b16 v[84:85], v20 offset:160
  v_mfma_f32_16x16x32_bf16 v[104:107], v[72:75], v[48:51], v[104:107]
  ds_read_b64_tr_b16 v[86:87], v20 offset:4512
  ds_read_b64_tr_b16 v[88:89], v20 offset:192
  v_mfma_f32_16x16x32_bf16 v[108:111], v[72:75], v[52:55], v[108:111]
  ds_read_b64_tr_b16 v[90:91], v20 offset:4544
  s_waitcnt lgkmcnt(10)
  v_mfma_f32_16x16x32_bf16 v[112:115], v[76:79], v[40:43], v[112:115]
  ds_read_b64_tr_b16 v[92:93], v21 offset:224
  ds_read_b64_tr_b16 v[94:95], v21 offset:4576
  v_mfma_f32_16x16x32_bf16 v[116:119], v[76:79], v[44:47], v[116:119]
  ds_read_b64_tr_b16 v[72:73], v20 offset:320
  ds_read_b64_tr_b16 v[74:75], v20 offset:4672
  v_mfma_f32_16x16x32_bf16 v[120:123], v[76:79], v[48:51], v[120:123]
  v_mfma_f32_16x16x32_bf16 v[124:127], v[76:79], v[52:55], v[124:127]
  ds_read_b64_tr_b16 v[76:77], v20 offset:352
  s_waitcnt lgkmcnt(13)
  v_mfma_f32_16x16x32_bf16 v[192:195], v[80:83], v[40:43], v[192:195]
  ds_read_b64_tr_b16 v[78:79], v20 offset:4704
  s_add_u32 s43, s43, 1
  v_mfma_f32_16x16x32_bf16 v[196:199], v[80:83], v[44:47], v[196:199]
  ds_read_b64_tr_b16 v[80:81], v21 offset:384
  s_waitcnt lgkmcnt(9)
  v_mfma_f32_16x16x32_bf16 v[128:131], v[84:87], v[40:43], v[128:131]
  ds_read_b64_tr_b16 v[82:83], v21 offset:4736
  s_cmp_eq_u32 s43, 3
  v_mfma_f32_16x16x32_bf16 v[132:135], v[84:87], v[44:47], v[132:135]
  s_cselect_b32 s43, 0, s43
  s_cselect_b32 s45, s53, s52
  v_mfma_f32_16x16x32_bf16 v[136:139], v[84:87], v[48:51], v[136:139]
  s_cselect_b32 s46, s55, s54
  v_mfma_f32_16x16x32_bf16 v[140:143], v[84:87], v[52:55], v[140:143]
  ds_read_b64_tr_b16 v[84:85], v20 offset:17408
  s_waitcnt lgkmcnt(9)
  v_mfma_f32_16x16x32_bf16 v[144:147], v[88:91], v[40:43], v[144:147]
  ds_read_b64_tr_b16 v[86:87], v20 offset:21760
  v_mfma_f32_16x16x32_bf16 v[148:151], v[88:91], v[44:47], v[148:151]
  v_mfma_f32_16x16x32_bf16 v[152:155], v[88:91], v[48:51], v[152:155]
  v_mfma_f32_16x16x32_bf16 v[156:159], v[88:91], v[52:55], v[156:159]
  ds_read_b64_tr_b16 v[88:89], v20 offset:17440
  s_waitcnt lgkmcnt(9)
  v_mfma_f32_16x16x32_bf16 v[200:203], v[92:95], v[40:43], v[200:203]
  ds_read_b64_tr_b16 v[90:91], v20 offset:21792
  v_add_u32 v16, s45, v16
  v_mfma_f32_16x16x32_bf16 v[204:207], v[92:95], v[44:47], v[204:207]
  ds_read_b64_tr_b16 v[92:93], v21 offset:17472
  s_waitcnt lgkmcnt(9)
  v_mfma_f32_16x16x32_bf16 v[160:163], v[72:75], v[40:43], v[160:163]
  ds_read_b64_tr_b16 v[94:95], v21 offset:21824
  v_add_u32 v17, s45, v17
  v_mfma_f32_16x16x32_bf16 v[164:167], v[72:75], v[44:47], v[164:167]
  v_add_u32 v18, s45, v18
  v_add_u32 v19, s45, v19
  v_mfma_f32_16x16x32_bf16 v[168:171], v[72:75], v[48:51], v[168:171]
  v_mfma_f32_16x16x32_bf16 v[172:175], v[72:75], v[52:55], v[172:175]
  ds_read_b64_tr_b16 v[72:73], v20 offset:17568
  s_waitcnt lgkmcnt(9)
  v_mfma_f32_16x16x32_bf16 v[176:179], v[76:79], v[40:43], v[176:179]
  ds_read_b64_tr_b16 v[74:75], v20 offset:21920
  v_mfma_f32_16x16x32_bf16 v[180:183], v[76:79], v[44:47], v[180:183]
  v_mfma_f32_16x16x32_bf16 v[184:187], v[76:79], v[48:51], v[184:187]
  v_mfma_f32_16x16x32_bf16 v[188:191], v[76:79], v[52:55], v[188:191]
  ds_read_b64_tr_b16 v[76:77], v20 offset:17600
  s_waitcnt lgkmcnt(9)
  v_mfma_f32_16x16x32_bf16 v[208:211], v[80:83], v[40:43], v[208:211]
  ds_read_b64_tr_b16 v[78:79], v20 offset:21952
  v_mfma_f32_16x16x32_bf16 v[212:215], v[80:83], v[44:47], v[212:215]
  ds_read_b64_tr_b16 v[80:81], v21 offset:17632
  s_waitcnt lgkmcnt(9)
  v_mfma_f32_16x16x32_bf16 v[96:99], v[84:87], v[56:59], v[96:99]
  ds_read_b64_tr_b16 v[82:83], v21 offset:21984
  v_mfma_f32_16x16x32_bf16 v[100:103], v[84:87], v[60:63], v[100:103]
  v_mfma_f32_16x16x32_bf16 v[104:107], v[84:87], v[64:67], v[104:107]
  v_mfma_f32_16x16x32_bf16 v[108:111], v[84:87], v[68:71], v[108:111]
  ds_read_b64_tr_b16 v[84:85], v20 offset:17728
  s_waitcnt lgkmcnt(9)
  v_mfma_f32_16x16x32_bf16 v[112:115], v[88:91], v[56:59], v[112:115]
  ds_read_b64_tr_b16 v[86:87], v20 offset:22080
  s_add_u32 s42, s42, 1
  v_mfma_f32_16x16x32_bf16 v[116:119], v[88:91], v[60:63], v[116:119]
  v_mfma_f32_16x16x32_bf16 v[120:123], v[88:91], v[64:67], v[120:123]
  v_mfma_f32_16x16x32_bf16 v[124:127], v[88:91], v[68:71], v[124:127]
  ds_read_b64_tr_b16 v[88:89], v20 offset:17760
  s_waitcnt lgkmcnt(9)
  v_mfma_f32_16x16x32_bf16 v[192:195], v[92:95], v[56:59], v[192:195]
  ds_read_b64_tr_b16 v[90:91], v20 offset:22112
  v_mfma_f32_16x16x32_bf16 v[196:199], v[92:95], v[60:63], v[196:199]
  ds_read_b64_tr_b16 v[92:93], v21 offset:17792
  s_waitcnt lgkmcnt(9)
  v_mfma_f32_16x16x32_bf16 v[128:131], v[72:75], v[56:59], v[128:131]
  ds_read_b64_tr_b16 v[94:95], v21 offset:22144
  v_mfma_f32_16x16x32_bf16 v[132:135], v[72:75], v[60:63], v[132:135]
  v_mfma_f32_16x16x32_bf16 v[136:139], v[72:75], v[64:67], v[136:139]
  v_mfma_f32_16x16x32_bf16 v[140:143], v[72:75], v[68:71], v[140:143]
  s_waitcnt lgkmcnt(8)
  v_mfma_f32_16x16x32_bf16 v[144:147], v[76:79], v[56:59], v[144:147]
  v_mfma_f32_16x16x32_bf16 v[148:151], v[76:79], v[60:63], v[148:151]
  v_mfma_f32_16x16x32_bf16 v[152:155], v[76:79], v[64:67], v[152:155]
  v_mfma_f32_16x16x32_bf16 v[156:159], v[76:79], v[68:71], v[156:159]
  v_add_u32 v20, s46, v20
  v_add_u32 v21, s46, v21
  s_cmp_lt_u32 s42, 10
  s_waitcnt lgkmcnt(0)
  s_barrier
  s_cbranch_scc1 k1_kernel_loop_t
  v_mfma_f32_16x16x32_bf16 v[200:203], v[80:83], v[56:59], v[200:203]
  v_mfma_f32_16x16x32_bf16 v[204:207], v[80:83], v[60:63], v[204:207]
  v_mfma_f32_16x16x32_bf16 v[160:163], v[84:87], v[56:59], v[160:163]
  v_mfma_f32_16x16x32_bf16 v[164:167], v[84:87], v[60:63], v[164:167]
  v_mfma_f32_16x16x32_bf16 v[168:171], v[84:87], v[64:67], v[168:171]
  v_mfma_f32_16x16x32_bf16 v[172:175], v[84:87], v[68:71], v[172:175]
  v_mfma_f32_16x16x32_bf16 v[176:179], v[88:91], v[56:59], v[176:179]
  v_mfma_f32_16x16x32_bf16 v[180:183], v[88:91], v[60:63], v[180:183]
  v_mfma_f32_16x16x32_bf16 v[184:187], v[88:91], v[64:67], v[184:187]
  v_mfma_f32_16x16x32_bf16 v[188:191], v[88:91], v[68:71], v[188:191]
  v_mfma_f32_16x16x32_bf16 v[208:211], v[92:95], v[56:59], v[208:211]
  v_mfma_f32_16x16x32_bf16 v[212:215], v[92:95], v[60:63], v[212:215]
  s_waitcnt vmcnt(0)
  s_barrier
  s_mul_i32 s17, s21, 8388608
  s_mul_i32 s18, s20, 5120
  v_lshlrev_b32 v2, 4, v1
  v_add_u32 v3, s18, v2
  s_cmp_eq_u32 s56, 1.0
  s_cbranch_scc1 k1_kernel_nst0
  v_pk_mul_f32 v[96:97], v[96:97], s[56:57]
  v_pk_mul_f32 v[98:99], v[98:99], s[56:57]
  v_pk_mul_f32 v[100:101], v[100:101], s[56:57]
  v_pk_mul_f32 v[102:103], v[102:103], s[56:57]
  v_pk_mul_f32 v[104:105], v[104:105], s[56:57]
  v_pk_mul_f32 v[106:107], v[106:107], s[56:57]
  v_pk_mul_f32 v[108:109], v[108:109], s[56:57]
  v_pk_mul_f32 v[110:111], v[110:111], s[56:57]
  v_pk_mul_f32 v[112:113], v[112:113], s[56:57]
  v_pk_mul_f32 v[114:115], v[114:115], s[56:57]
  v_pk_mul_f32 v[116:117], v[116:117], s[56:57]
  v_pk_mul_f32 v[118:119], v[118:119], s[56:57]
  v_pk_mul_f32 v[120:121], v[120:121], s[56:57]
  v_pk_mul_f32 v[122:123], v[122:123], s[56:57]
  v_pk_mul_f32 v[124:125], v[124:125], s[56:57]
  v_pk_mul_f32 v[126:127], v[126:127], s[56:57]
  v_pk_mul_f32 v[192:193], v[192:193], s[56:57]
  v_pk_mul_f32 v[194:195], v[194:195], s[56:57]
  v_pk_mul_f32 v[196:197], v[196:197], s[56:57]
  v_pk_mul_f32 v[198:199], v[198:199], s[56:57]
k1_kernel_nst0:
  v_mad_u32_u24 v48, v28, v25, v22
  v_cvt_pk_bf16_f32 v40, v96, v97
  v_cvt_pk_bf16_f32 v41, v98, v99
  ds_write_b64 v48, v[40:41] offset:0
  v_mad_u32_u24 v49, v29, v25, v22
  v_cvt_pk_bf16_f32 v42, v100, v101
  v_cvt_pk_bf16_f32 v43, v102, v103
  ds_write_b64 v49, v[42:43] offset:0
  v_mad_u32_u24 v50, v30, v25, v22
  v_cvt_pk_bf16_f32 v44, v104, v105
  v_cvt_pk_bf16_f32 v45, v106, v107
  ds_write_b64 v50, v[44:45] offset:0
  v_mad_u32_u24 v51, v31, v25, v22
  v_cvt_pk_bf16_f32 v46, v108, v109
  v_cvt_pk_bf16_f32 v47, v110, v111
  ds_write_b64 v51, v[46:47] offset:0
  v_mad_u32_u24 v48, v28, v26, v23
  v_cvt_pk_bf16_f32 v40, v112, v113
  v_cvt_pk_bf16_f32 v41, v114, v115
  ds_write_b64 v48, v[40:41] offset:0
  v_mad_u32_u24 v49, v29, v26, v23
  v_cvt_pk_bf16_f32 v42, v116, v117
  v_cvt_pk_bf16_f32 v43, v118, v119
  ds_write_b64 v49, v[42:43] offset:0
  v_mad_u32_u24 v50, v30, v26, v23
  v_cvt_pk_bf16_f32 v44, v120, v121
  v_cvt_pk_bf16_f32 v45, v122, v123
  ds_write_b64 v50, v[44:45] offset:0
  v_mad_u32_u24 v51, v31, v26, v23
  v_cvt_pk_bf16_f32 v46, v124, v125
  v_cvt_pk_bf16_f32 v47, v126, v127
  ds_write_b64 v51, v[46:47] offset:0
  v_mad_u32_u24 v48, v28, v27, v24
  v_cvt_pk_bf16_f32 v40, v192, v193
  v_cvt_pk_bf16_f32 v41, v194, v195
  ds_write_b64 v48, v[40:41] offset:0
  v_mad_u32_u24 v49, v29, v27, v24
  v_cvt_pk_bf16_f32 v42, v196, v197
  v_cvt_pk_bf16_f32 v43, v198, v199
  ds_write_b64 v49, v[42:43] offset:0
  s_waitcnt lgkmcnt(0)
  s_barrier
  ds_read_b128 v[56:59], v3 offset:0
  ds_read_b128 v[60:63], v3 offset:1024
  ds_read_b128 v[64:67], v3 offset:2048
  ds_read_b128 v[68:71], v3 offset:3072
  ds_read_b128 v[72:75], v3 offset:4096
  s_cmp_eq_u32 s58, 1.0
  s_cbranch_scc1 k1_kernel_nst1
  v_pk_mul_f32 v[128:129], v[128:129], s[58:59]
  v_pk_mul_f32 v[130:131], v[130:131], s[58:59]
  v_pk_mul_f32 v[132:133], v[132:133], s[58:59]
  v_pk_mul_f32 v[134:135], v[134:135], s[58:59]
  v_pk_mul_f32 v[136:137], v[136:137], s[58:59]
  v_pk_mul_f32 v[138:139], v[138:139], s[58:59]
  v_pk_mul_f32 v[140:141], v[140:141], s[58:59]
  v_pk_mul_f32 v[142:143], v[142:143], s[58:59]
  v_pk_mul_f32 v[144:145], v[144:145], s[58:59]
  v_pk_mul_f32 v[146:147], v[146:147], s[58:59]
  v_pk_mul_f32 v[148:149], v[148:149], s[58:59]
  v_pk_mul_f32 v[150:151], v[150:151], s[58:59]
  v_pk_mul_f32 v[152:153], v[152:153], s[58:59]
  v_pk_mul_f32 v[154:155], v[154:155], s[58:59]
  v_pk_mul_f32 v[156:157], v[156:157], s[58:59]
  v_pk_mul_f32 v[158:159], v[158:159], s[58:59]
  v_pk_mul_f32 v[200:201], v[200:201], s[58:59]
  v_pk_mul_f32 v[202:203], v[202:203], s[58:59]
  v_pk_mul_f32 v[204:205], v[204:205], s[58:59]
  v_pk_mul_f32 v[206:207], v[206:207], s[58:59]
k1_kernel_nst1:
  v_mad_u32_u24 v48, v28, v25, v22
  v_cvt_pk_bf16_f32 v40, v128, v129
  v_cvt_pk_bf16_f32 v41, v130, v131
  ds_write_b64 v48, v[40:41] offset:20480
  v_mad_u32_u24 v49, v29, v25, v22
  v_cvt_pk_bf16_f32 v42, v132, v133
  v_cvt_pk_bf16_f32 v43, v134, v135
  ds_write_b64 v49, v[42:43] offset:20480
  v_mad_u32_u24 v50, v30, v25, v22
  v_cvt_pk_bf16_f32 v44, v136, v137
  v_cvt_pk_bf16_f32 v45, v138, v139
  ds_write_b64 v50, v[44:45] offset:20480
  v_mad_u32_u24 v51, v31, v25, v22
  v_cvt_pk_bf16_f32 v46, v140, v141
  v_cvt_pk_bf16_f32 v47, v142, v143
  ds_write_b64 v51, v[46:47] offset:20480
  v_mad_u32_u24 v48, v28, v26, v23
  v_cvt_pk_bf16_f32 v40, v144, v145
  v_cvt_pk_bf16_f32 v41, v146, v147
  ds_write_b64 v48, v[40:41] offset:20480
  v_mad_u32_u24 v49, v29, v26, v23
  v_cvt_pk_bf16_f32 v42, v148, v149
  v_cvt_pk_bf16_f32 v43, v150, v151
  ds_write_b64 v49, v[42:43] offset:20480
  v_mad_u32_u24 v50, v30, v26, v23
  v_cvt_pk_bf16_f32 v44, v152, v153
  v_cvt_pk_bf16_f32 v45, v154, v155
  ds_write_b64 v50, v[44:45] offset:20480
  v_mad_u32_u24 v51, v31, v26, v23
  v_cvt_pk_bf16_f32 v46, v156, v157
  v_cvt_pk_bf16_f32 v47, v158, v159
  ds_write_b64 v51, v[46:47] offset:20480
  v_mad_u32_u24 v48, v28, v27, v24
  v_cvt_pk_bf16_f32 v40, v200, v201
  v_cvt_pk_bf16_f32 v41, v202, v203
  ds_write_b64 v48, v[40:41] offset:20480
  v_mad_u32_u24 v49, v29, v27, v24
  v_cvt_pk_bf16_f32 v42, v204, v205
  v_cvt_pk_bf16_f32 v43, v206, v207
  ds_write_b64 v49, v[42:43] offset:20480
  s_mul_i32 s14, s23, 3
  s_add_u32 s14, s14, 0
  s_and_b32 s15, s14, 7
  s_lshl_b32 s15, s15, 2
  s_add_u32 s15, s15, s20
  s_lshr_b32 s14, s14, 3
  s_mul_i32 s18, s15, 81920
  s_lshl_b32 s18, s18, s14
  s_mul_i32 s14, s14, 2621440
  s_add_u32 s14, s14, s17
  s_add_u32 s14, s14, s18
  s_lshl_b32 s19, s22, 11
  s_add_u32 s18, s14, s19
  s_lshl_b32 s19, s22, 10
  s_add_u32 s16, s14, s19
  s_add_u32 s15, s18, 0
  s_waitcnt lgkmcnt(14)
  buffer_store_dwordx4 v[56:59], v2, s[36:39], s15 offen sc1
  s_add_u32 s15, s18, 1024
  s_waitcnt lgkmcnt(13)
  buffer_store_dwordx4 v[60:63], v2, s[36:39], s15 offen sc1
  s_add_u32 s15, s18, 32768
  s_waitcnt lgkmcnt(12)
  buffer_store_dwordx4 v[64:67], v2, s[36:39], s15 offen sc1
  s_add_u32 s15, s18, 33792
  s_waitcnt lgkmcnt(11)
  buffer_store_dwordx4 v[68:71], v2, s[36:39], s15 offen sc1
  s_add_u32 s15, s16, 65536
  s_waitcnt lgkmcnt(10)
  buffer_store_dwordx4 v[72:75], v2, s[36:39], s15 offen sc1
  s_waitcnt lgkmcnt(0)
  s_barrier
  ds_read_b128 v[96:99], v3 offset:20480
  ds_read_b128 v[100:103], v3 offset:21504
  ds_read_b128 v[104:107], v3 offset:22528
  ds_read_b128 v[108:111], v3 offset:23552
  ds_read_b128 v[112:115], v3 offset:24576
  s_cmp_eq_u32 s60, 1.0
  s_cbranch_scc1 k1_kernel_nst2
  v_pk_mul_f32 v[160:161], v[160:161], s[60:61]
  v_pk_mul_f32 v[162:163], v[162:163], s[60:61]
  v_pk_mul_f32 v[164:165], v[164:165], s[60:61]
  v_pk_mul_f32 v[166:167], v[166:167], s[60:61]
  v_pk_mul_f32 v[168:169], v[168:169], s[60:61]
  v_pk_mul_f32 v[170:171], v[170:171], s[60:61]
  v_pk_mul_f32 v[172:173], v[172:173], s[60:61]
  v_pk_mul_f32 v[174:175], v[174:175], s[60:61]
  v_pk_mul_f32 v[176:177], v[176:177], s[60:61]
  v_pk_mul_f32 v[178:179], v[178:179], s[60:61]
  v_pk_mul_f32 v[180:181], v[180:181], s[60:61]
  v_pk_mul_f32 v[182:183], v[182:183], s[60:61]
  v_pk_mul_f32 v[184:185], v[184:185], s[60:61]
  v_pk_mul_f32 v[186:187], v[186:187], s[60:61]
  v_pk_mul_f32 v[188:189], v[188:189], s[60:61]
  v_pk_mul_f32 v[190:191], v[190:191], s[60:61]
  v_pk_mul_f32 v[208:209], v[208:209], s[60:61]
  v_pk_mul_f32 v[210:211], v[210:211], s[60:61]
  v_pk_mul_f32 v[212:213], v[212:213], s[60:61]
  v_pk_mul_f32 v[214:215], v[214:215], s[60:61]
k1_kernel_nst2:
  v_mad_u32_u24 v48, v28, v25, v22
  v_cvt_pk_bf16_f32 v40, v160, v161
  v_cvt_pk_bf16_f32 v41, v162, v163
  ds_write_b64 v48, v[40:41] offset:40960
  v_mad_u32_u24 v49, v29, v25, v22
  v_cvt_pk_bf16_f32 v42, v164, v165
  v_cvt_pk_bf16_f32 v43, v166, v167
  ds_write_b64 v49, v[42:43] offset:40960
  v_mad_u32_u24 v50, v30, v25, v22
  v_cvt_pk_bf16_f32 v44, v168, v169
  v_cvt_pk_bf16_f32 v45, v170, v171
  ds_write_b64 v50, v[44:45] offset:40960
  v_mad_u32_u24 v51, v31, v25, v22
  v_cvt_pk_bf16_f32 v46, v172, v173
  v_cvt_pk_bf16_f32 v47, v174, v175
  ds_write_b64 v51, v[46:47] offset:40960
  v_mad_u32_u24 v48, v28, v26, v23
  v_cvt_pk_bf16_f32 v40, v176, v177
  v_cvt_pk_bf16_f32 v41, v178, v179
  ds_write_b64 v48, v[40:41] offset:40960
  v_mad_u32_u24 v49, v29, v26, v23
  v_cvt_pk_bf16_f32 v42, v180, v181
  v_cvt_pk_bf16_f32 v43, v182, v183
  ds_write_b64 v49, v[42:43] offset:40960
  v_mad_u32_u24 v50, v30, v26, v23
  v_cvt_pk_bf16_f32 v44, v184, v185
  v_cvt_pk_bf16_f32 v45, v186, v187
  ds_write_b64 v50, v[44:45] offset:40960
  v_mad_u32_u24 v51, v31, v26, v23
  v_cvt_pk_bf16_f32 v46, v188, v189
  v_cvt_pk_bf16_f32 v47, v190, v191
  ds_write_b64 v51, v[46:47] offset:40960
  v_mad_u32_u24 v48, v28, v27, v24
  v_cvt_pk_bf16_f32 v40, v208, v209
  v_cvt_pk_bf16_f32 v41, v210, v211
  ds_write_b64 v48, v[40:41] offset:40960
  v_mad_u32_u24 v49, v29, v27, v24
  v_cvt_pk_bf16_f32 v42, v212, v213
  v_cvt_pk_bf16_f32 v43, v214, v215
  ds_write_b64 v49, v[42:43] offset:40960
  s_mul_i32 s14, s23, 3
  s_add_u32 s14, s14, 1
  s_and_b32 s15, s14, 7
  s_lshl_b32 s15, s15, 2
  s_add_u32 s15, s15, s20
  s_lshr_b32 s14, s14, 3
  s_mul_i32 s18, s15, 81920
  s_lshl_b32 s18, s18, s14
  s_mul_i32 s14, s14, 2621440
  s_add_u32 s14, s14, s17
  s_add_u32 s14, s14, s18
  s_lshl_b32 s19, s22, 11
  s_add_u32 s18, s14, s19
  s_lshl_b32 s19, s22, 10
  s_add_u32 s16, s14, s19
  s_add_u32 s15, s18, 0
  s_waitcnt lgkmcnt(14)
  buffer_store_dwordx4 v[96:99], v2, s[36:39], s15 offen sc1
  s_add_u32 s15, s18, 1024
  s_waitcnt lgkmcnt(13)
  buffer_store_dwordx4 v[100:103], v2, s[36:39], s15 offen sc1
  s_add_u32 s15, s18, 32768
  s_waitcnt lgkmcnt(12)
  buffer_store_dwordx4 v[104:107], v2, s[36:39], s15 offen sc1
  s_add_u32 s15, s18, 33792
  s_waitcnt lgkmcnt(11)
  buffer_store_dwordx4 v[108:111], v2, s[36:39], s15 offen sc1
  s_add_u32 s15, s16, 65536
  s_waitcnt lgkmcnt(10)
  buffer_store_dwordx4 v[112:115], v2, s[36:39], s15 offen sc1
  s_waitcnt lgkmcnt(0)
  s_barrier
  ds_read_b128 v[128:131], v3 offset:40960
  ds_read_b128 v[132:135], v3 offset:41984
  ds_read_b128 v[136:139], v3 offset:43008
  ds_read_b128 v[140:143], v3 offset:44032
  ds_read_b128 v[144:147], v3 offset:45056
  s_mul_i32 s14, s23, 3
  s_add_u32 s14, s14, 2
  s_and_b32 s15, s14, 7
  s_lshl_b32 s15, s15, 2
  s_add_u32 s15, s15, s20
  s_lshr_b32 s14, s14, 3
  s_mul_i32 s18, s15, 81920
  s_lshl_b32 s18, s18, s14
  s_mul_i32 s14, s14, 2621440
  s_add_u32 s14, s14, s17
  s_add_u32 s14, s14, s18
  s_lshl_b32 s19, s22, 11
  s_add_u32 s18, s14, s19
  s_lshl_b32 s19, s22, 10
  s_add_u32 s16, s14, s19
  s_add_u32 s15, s18, 0
  s_waitcnt lgkmcnt(4)
  buffer_store_dwordx4 v[128:131], v2, s[36:39], s15 offen sc1
  s_add_u32 s15, s18, 1024
  s_waitcnt lgkmcnt(3)
  buffer_store_dwordx4 v[132:135], v2, s[36:39], s15 offen sc1
  s_add_u32 s15, s18, 32768
  s_waitcnt lgkmcnt(2)
  buffer_store_dwordx4 v[136:139], v2, s[36:39], s15 offen sc1
  s_add_u32 s15, s18, 33792
  s_waitcnt lgkmcnt(1)
  buffer_store_dwordx4 v[140:143], v2, s[36:39], s15 offen sc1
  s_add_u32 s15, s16, 65536
  s_waitcnt lgkmcnt(0)
  buffer_store_dwordx4 v[144:147], v2, s[36:39], s15 offen sc1
  s_endpgm
k1_kernel_vm:
.p2align 6
k1_kernel_loop_m:
  ds_read_b128 v[40:43], v16 offset:0
  ds_read_b128 v[44:47], v16 offset:2048
  v_mfma_f32_16x16x32_bf16 v[200:203], v[56:59], v[80:83], v[200:203]
  ds_read_b128 v[48:51], v18 offset:0
  ds_read_b128 v[52:55], v18 offset:2048
  v_mfma_f32_16x16x32_bf16 v[204:207], v[60:63], v[80:83], v[204:207]
  ds_read_b64_tr_b16 v[72:73], v20 offset:0
  ds_read_b64_tr_b16 v[74:75], v20 offset:4352
  v_mfma_f32_16x16x32_bf16 v[160:163], v[56:59], v[84:87], v[160:163]
  ds_read_b64_tr_b16 v[76:77], v20 offset:32
  ds_read_b64_tr_b16 v[78:79], v20 offset:4384
  v_mfma_f32_16x16x32_bf16 v[164:167], v[60:63], v[84:87], v[164:167]
  ds_read_b64_tr_b16 v[80:81], v21 offset:64
  ds_read_b64_tr_b16 v[82:83], v21 offset:4416
  v_mfma_f32_16x16x32_bf16 v[168:171], v[64:67], v[84:87], v[168:171]
  v_mfma_f32_16x16x32_bf16 v[172:175], v[68:71], v[84:87], v[172:175]
  v_mfma_f32_16x16x32_bf16 v[176:179], v[56:59], v[88:91], v[176:179]
  v_mfma_f32_16x16x32_bf16 v[180:183], v[60:63], v[88:91], v[180:183]
  v_mfma_f32_16x16x32_bf16 v[184:187], v[64:67], v[88:91], v[184:187]
  v_mfma_f32_16x16x32_bf16 v[188:191], v[68:71], v[88:91], v[188:191]
  v_mfma_f32_16x16x32_bf16 v[208:211], v[56:59], v[92:95], v[208:211]
  v_mfma_f32_16x16x32_bf16 v[212:215], v[60:63], v[92:95], v[212:215]
  ds_read_b128 v[56:59], v17 offset:0
  s_waitcnt lgkmcnt(5)
  v_mfma_f32_16x16x32_bf16 v[96:99], v[72:75], v[40:43], v[96:99]
  ds_read_b128 v[60:63], v17 offset:2048
  ds_read_b128 v[64:67], v19 offset:0
  v_mfma_f32_16x16x32_bf16 v[100:103], v[72:75], v[44:47], v[100:103]
  ds_read_b128 v[68:71], v19 offset:2048
  ds_read_b64_tr_b16 v[84:85], v20 offset:160
  v_mfma_f32_16x16x32_bf16 v[104:107], v[72:75], v[48:51], v[104:107]
  ds_read_b64_tr_b16 v[86:87], v20 offset:4512
  ds_read_b64_tr_b16 v[88:89], v20 offset:192
  v_mfma_f32_16x16x32_bf16 v[108:111], v[72:75], v[52:55], v[108:111]
  ds_read_b64_tr_b16 v[90:91], v20 offset:4544
  s_waitcnt lgkmcnt(10)
  v_mfma_f32_16x16x32_bf16 v[112:115], v[76:79], v[40:43], v[112:115]
  ds_read_b64_tr_b16 v[92:93], v21 offset:224
  ds_read_b64_tr_b16 v[94:95], v21 offset:4576
  v_mfma_f32_16x16x32_bf16 v[116:119], v[76:79], v[44:47], v[116:119]
  ds_read_b64_tr_b16 v[72:73], v20 offset:320
  ds_read_b64_tr_b16 v[74:75], v20 offset:4672
  v_mfma_f32_16x16x32_bf16 v[120:123], v[76:79], v[48:51], v[120:123]
  v_mfma_f32_16x16x32_bf16 v[124:127], v[76:79], v[52:55], v[124:127]
  ds_read_b64_tr_b16 v[76:77], v20 offset:352
  s_waitcnt lgkmcnt(13)
  v_mfma_f32_16x16x32_bf16 v[192:195], v[80:83], v[40:43], v[192:195]
  ds_read_b64_tr_b16 v[78:79], v20 offset:4704
  s_add_u32 s43, s43, 1
  v_mfma_f32_16x16x32_bf16 v[196:199], v[80:83], v[44:47], v[196:199]
  ds_read_b64_tr_b16 v[80:81], v21 offset:384
  s_waitcnt lgkmcnt(9)
  v_mfma_f32_16x16x32_bf16 v[128:131], v[40:43], v[84:87], v[128:131]
  ds_read_b64_tr_b16 v[82:83], v21 offset:4736
  s_cmp_eq_u32 s43, 3
  v_mfma_f32_16x16x32_bf16 v[132:135], v[44:47], v[84:87], v[132:135]
  s_cselect_b32 s43, 0, s43
  s_cselect_b32 s45, s53, s52
  v_mfma_f32_16x16x32_bf16 v[136:139], v[48:51], v[84:87], v[136:139]
  s_cselect_b32 s46, s55, s54
  v_mfma_f32_16x16x32_bf16 v[140:143], v[52:55], v[84:87], v[140:143]
  ds_read_b64_tr_b16 v[84:85], v20 offset:17408
  s_waitcnt lgkmcnt(9)
  v_mfma_f32_16x16x32_bf16 v[144:147], v[40:43], v[88:91], v[144:147]
  ds_read_b64_tr_b16 v[86:87], v20 offset:21760
  v_mfma_f32_16x16x32_bf16 v[148:151], v[44:47], v[88:91], v[148:151]
  v_mfma_f32_16x16x32_bf16 v[152:155], v[48:51], v[88:91], v[152:155]
  v_mfma_f32_16x16x32_bf16 v[156:159], v[52:55], v[88:91], v[156:159]
  ds_read_b64_tr_b16 v[88:89], v20 offset:17440
  s_waitcnt lgkmcnt(9)
  v_mfma_f32_16x16x32_bf16 v[200:203], v[40:43], v[92:95], v[200:203]
  ds_read_b64_tr_b16 v[90:91], v20 offset:21792
  v_add_u32 v16, s45, v16
  v_mfma_f32_16x16x32_bf16 v[204:207], v[44:47], v[92:95], v[204:207]
  ds_read_b64_tr_b16 v[92:93], v21 offset:17472
  s_waitcnt lgkmcnt(9)
  v_mfma_f32_16x16x32_bf16 v[160:163], v[40:43], v[72:75], v[160:163]
  ds_read_b64_tr_b16 v[94:95], v21 offset:21824
  v_add_u32 v17, s45, v17
  v_mfma_f32_16x16x32_bf16 v[164:167], v[44:47], v[72:75], v[164:167]
  v_add_u32 v18, s45, v18
  v_add_u32 v19, s45, v19
  v_mfma_f32_16x16x32_bf16 v[168:171], v[48:51], v[72:75], v[168:171]
  v_mfma_f32_16x16x32_bf16 v[172:175], v[52:55], v[72:75], v[172:175]
  ds_read_b64_tr_b16 v[72:73], v20 offset:17568
  s_waitcnt lgkmcnt(9)
  v_mfma_f32_16x16x32_bf16 v[176:179], v[40:43], v[76:79], v[176:179]
  ds_read_b64_tr_b16 v[74:75], v20 offset:21920
  v_mfma_f32_16x16x32_bf16 v[180:183], v[44:47], v[76:79], v[180:183]
  v_mfma_f32_16x16x32_bf16 v[184:187], v[48:51], v[76:79], v[184:187]
  v_mfma_f32_16x16x32_bf16 v[188:191], v[52:55], v[76:79], v[188:191]
  ds_read_b64_tr_b16 v[76:77], v20 offset:17600
  s_waitcnt lgkmcnt(9)
  v_mfma_f32_16x16x32_bf16 v[208:211], v[40:43], v[80:83], v[208:211]
  ds_read_b64_tr_b16 v[78:79], v20 offset:21952
  v_mfma_f32_16x16x32_bf16 v[212:215], v[44:47], v[80:83], v[212:215]
  ds_read_b64_tr_b16 v[80:81], v21 offset:17632
  s_waitcnt lgkmcnt(9)
  v_mfma_f32_16x16x32_bf16 v[96:99], v[84:87], v[56:59], v[96:99]
  ds_read_b64_tr_b16 v[82:83], v21 offset:21984
  v_mfma_f32_16x16x32_bf16 v[100:103], v[84:87], v[60:63], v[100:103]
  v_mfma_f32_16x16x32_bf16 v[104:107], v[84:87], v[64:67], v[104:107]
  v_mfma_f32_16x16x32_bf16 v[108:111], v[84:87], v[68:71], v[108:111]
  ds_read_b64_tr_b16 v[84:85], v20 offset:17728
  s_waitcnt lgkmcnt(9)
  v_mfma_f32_16x16x32_bf16 v[112:115], v[88:91], v[56:59], v[112:115]
  ds_read_b64_tr_b16 v[86:87], v20 offset:22080
  s_add_u32 s42, s42, 1
  v_mfma_f32_16x16x32_bf16 v[116:119], v[88:91], v[60:63], v[116:119]
  v_mfma_f32_16x16x32_bf16 v[120:123], v[88:91], v[64:67], v[120:123]
  v_mfma_f32_16x16x32_bf16 v[124:127], v[88:91], v[68:71], v[124:127]
  ds_read_b64_tr_b16 v[88:89], v20 offset:17760
  s_waitcnt lgkmcnt(9)
  v_mfma_f32_16x16x32_bf16 v[192:195], v[92:95], v[56:59], v[192:195]
  ds_read_b64_tr_b16 v[90:91], v20 offset:22112
  v_mfma_f32_16x16x32_bf16 v[196:199], v[92:95], v[60:63], v[196:199]
  ds_read_b64_tr_b16 v[92:93], v21 offset:17792
  s_waitcnt lgkmcnt(9)
  v_mfma_f32_16x16x32_bf16 v[128:131], v[56:59], v[72:75], v[128:131]
  ds_read_b64_tr_b16 v[94:95], v21 offset:22144
  v_mfma_f32_16x16x32_bf16 v[132:135], v[60:63], v[72:75], v[132:135]
  v_mfma_f32_16x16x32_bf16 v[136:139], v[64:67], v[72:75], v[136:139]
  v_mfma_f32_16x16x32_bf16 v[140:143], v[68:71], v[72:75], v[140:143]
  s_waitcnt lgkmcnt(8)
  v_mfma_f32_16x16x32_bf16 v[144:147], v[56:59], v[76:79], v[144:147]
  v_mfma_f32_16x16x32_bf16 v[148:151], v[60:63], v[76:79], v[148:151]
  v_mfma_f32_16x16x32_bf16 v[152:155], v[64:67], v[76:79], v[152:155]
  v_mfma_f32_16x16x32_bf16 v[156:159], v[68:71], v[76:79], v[156:159]
  v_add_u32 v20, s46, v20
  v_add_u32 v21, s46, v21
  s_cmp_lt_u32 s42, 10
  s_waitcnt lgkmcnt(0)
  s_barrier
  s_cbranch_scc1 k1_kernel_loop_m
  v_mfma_f32_16x16x32_bf16 v[200:203], v[56:59], v[80:83], v[200:203]
  v_mfma_f32_16x16x32_bf16 v[204:207], v[60:63], v[80:83], v[204:207]
  v_mfma_f32_16x16x32_bf16 v[160:163], v[56:59], v[84:87], v[160:163]
  v_mfma_f32_16x16x32_bf16 v[164:167], v[60:63], v[84:87], v[164:167]
  v_mfma_f32_16x16x32_bf16 v[168:171], v[64:67], v[84:87], v[168:171]
  v_mfma_f32_16x16x32_bf16 v[172:175], v[68:71], v[84:87], v[172:175]
  v_mfma_f32_16x16x32_bf16 v[176:179], v[56:59], v[88:91], v[176:179]
  v_mfma_f32_16x16x32_bf16 v[180:183], v[60:63], v[88:91], v[180:183]
  v_mfma_f32_16x16x32_bf16 v[184:187], v[64:67], v[88:91], v[184:187]
  v_mfma_f32_16x16x32_bf16 v[188:191], v[68:71], v[88:91], v[188:191]
  v_mfma_f32_16x16x32_bf16 v[208:211], v[56:59], v[92:95], v[208:211]
  v_mfma_f32_16x16x32_bf16 v[212:215], v[60:63], v[92:95], v[212:215]
  s_waitcnt vmcnt(0)
  s_barrier
  s_mul_i32 s17, s21, 8388608
  s_mul_i32 s18, s20, 5120
  v_lshlrev_b32 v2, 4, v1
  v_add_u32 v3, s18, v2
  s_cmp_eq_u32 s56, 1.0
  s_cbranch_scc1 k1_kernel_nsm0
  v_pk_mul_f32 v[96:97], v[96:97], s[56:57]
  v_pk_mul_f32 v[98:99], v[98:99], s[56:57]
  v_pk_mul_f32 v[100:101], v[100:101], s[56:57]
  v_pk_mul_f32 v[102:103], v[102:103], s[56:57]
  v_pk_mul_f32 v[104:105], v[104:105], s[56:57]
  v_pk_mul_f32 v[106:107], v[106:107], s[56:57]
  v_pk_mul_f32 v[108:109], v[108:109], s[56:57]
  v_pk_mul_f32 v[110:111], v[110:111], s[56:57]
  v_pk_mul_f32 v[112:113], v[112:113], s[56:57]
  v_pk_mul_f32 v[114:115], v[114:115], s[56:57]
  v_pk_mul_f32 v[116:117], v[116:117], s[56:57]
  v_pk_mul_f32 v[118:119], v[118:119], s[56:57]
  v_pk_mul_f32 v[120:121], v[120:121], s[56:57]
  v_pk_mul_f32 v[122:123], v[122:123], s[56:57]
  v_pk_mul_f32 v[124:125], v[124:125], s[56:57]
  v_pk_mul_f32 v[126:127], v[126:127], s[56:57]
  v_pk_mul_f32 v[192:193], v[192:193], s[56:57]
  v_pk_mul_f32 v[194:195], v[194:195], s[56:57]
  v_pk_mul_f32 v[196:197], v[196:197], s[56:57]
  v_pk_mul_f32 v[198:199], v[198:199], s[56:57]
k1_kernel_nsm0:
  v_mad_u32_u24 v48, v28, v25, v22
  v_cvt_pk_bf16_f32 v40, v96, v97
  v_cvt_pk_bf16_f32 v41, v98, v99
  ds_write_b64 v48, v[40:41] offset:0
  v_mad_u32_u24 v49, v29, v25, v22
  v_cvt_pk_bf16_f32 v42, v100, v101
  v_cvt_pk_bf16_f32 v43, v102, v103
  ds_write_b64 v49, v[42:43] offset:0
  v_mad_u32_u24 v50, v30, v25, v22
  v_cvt_pk_bf16_f32 v44, v104, v105
  v_cvt_pk_bf16_f32 v45, v106, v107
  ds_write_b64 v50, v[44:45] offset:0
  v_mad_u32_u24 v51, v31, v25, v22
  v_cvt_pk_bf16_f32 v46, v108, v109
  v_cvt_pk_bf16_f32 v47, v110, v111
  ds_write_b64 v51, v[46:47] offset:0
  v_mad_u32_u24 v48, v28, v26, v23
  v_cvt_pk_bf16_f32 v40, v112, v113
  v_cvt_pk_bf16_f32 v41, v114, v115
  ds_write_b64 v48, v[40:41] offset:0
  v_mad_u32_u24 v49, v29, v26, v23
  v_cvt_pk_bf16_f32 v42, v116, v117
  v_cvt_pk_bf16_f32 v43, v118, v119
  ds_write_b64 v49, v[42:43] offset:0
  v_mad_u32_u24 v50, v30, v26, v23
  v_cvt_pk_bf16_f32 v44, v120, v121
  v_cvt_pk_bf16_f32 v45, v122, v123
  ds_write_b64 v50, v[44:45] offset:0
  v_mad_u32_u24 v51, v31, v26, v23
  v_cvt_pk_bf16_f32 v46, v124, v125
  v_cvt_pk_bf16_f32 v47, v126, v127
  ds_write_b64 v51, v[46:47] offset:0
  v_mad_u32_u24 v48, v28, v27, v24
  v_cvt_pk_bf16_f32 v40, v192, v193
  v_cvt_pk_bf16_f32 v41, v194, v195
  ds_write_b64 v48, v[40:41] offset:0
  v_mad_u32_u24 v49, v29, v27, v24
  v_cvt_pk_bf16_f32 v42, v196, v197
  v_cvt_pk_bf16_f32 v43, v198, v199
  ds_write_b64 v49, v[42:43] offset:0
  s_waitcnt lgkmcnt(0)
  s_barrier
  ds_read_b128 v[56:59], v3 offset:0
  ds_read_b128 v[60:63], v3 offset:1024
  ds_read_b128 v[64:67], v3 offset:2048
  ds_read_b128 v[68:71], v3 offset:3072
  ds_read_b128 v[72:75], v3 offset:4096
  v_cvt_pk_bf16_f32 v40, v128, v129
  v_cvt_pk_bf16_f32 v41, v130, v131
  ds_write_b64 v32, v[40:41] offset:20480
  v_cvt_pk_bf16_f32 v42, v132, v133
  v_cvt_pk_bf16_f32 v43, v134, v135
  ds_write_b64 v32, v[42:43] offset:21120
  v_cvt_pk_bf16_f32 v44, v136, v137
  v_cvt_pk_bf16_f32 v45, v138, v139
  ds_write_b64 v33, v[44:45] offset:20480
  v_cvt_pk_bf16_f32 v46, v140, v141
  v_cvt_pk_bf16_f32 v47, v142, v143
  ds_write_b64 v33, v[46:47] offset:21120
  v_cvt_pk_bf16_f32 v40, v144, v145
  v_cvt_pk_bf16_f32 v41, v146, v147
  ds_write_b64 v34, v[40:41] offset:20480
  v_cvt_pk_bf16_f32 v42, v148, v149
  v_cvt_pk_bf16_f32 v43, v150, v151
  ds_write_b64 v34, v[42:43] offset:21120
  v_cvt_pk_bf16_f32 v44, v152, v153
  v_cvt_pk_bf16_f32 v45, v154, v155
  ds_write_b64 v35, v[44:45] offset:20480
  v_cvt_pk_bf16_f32 v46, v156, v157
  v_cvt_pk_bf16_f32 v47, v158, v159
  ds_write_b64 v35, v[46:47] offset:21120
  v_cvt_pk_bf16_f32 v40, v200, v201
  v_cvt_pk_bf16_f32 v41, v202, v203
  ds_write_b64 v36, v[40:41] offset:20480
  v_cvt_pk_bf16_f32 v42, v204, v205
  v_cvt_pk_bf16_f32 v43, v206, v207
  ds_write_b64 v36, v[42:43] offset:21120
  s_mul_i32 s14, s23, 3
  s_add_u32 s14, s14, 0
  s_and_b32 s15, s14, 7
  s_lshl_b32 s15, s15, 2
  s_add_u32 s15, s15, s20
  s_lshr_b32 s14, s14, 3
  s_mul_i32 s18, s15, 81920
  s_lshl_b32 s18, s18, s14
  s_mul_i32 s14, s14, 2621440
  s_add_u32 s14, s14, s17
  s_add_u32 s14, s14, s18
  s_lshl_b32 s19, s22, 11
  s_add_u32 s18, s14, s19
  s_lshl_b32 s19, s22, 10
  s_add_u32 s16, s14, s19
  s_add_u32 s15, s18, 0
  s_waitcnt lgkmcnt(14)
  buffer_store_dwordx4 v[56:59], v2, s[36:39], s15 offen sc1
  s_add_u32 s15, s18, 1024
  s_waitcnt lgkmcnt(13)
  buffer_store_dwordx4 v[60:63], v2, s[36:39], s15 offen sc1
  s_add_u32 s15, s18, 32768
  s_waitcnt lgkmcnt(12)
  buffer_store_dwordx4 v[64:67], v2, s[36:39], s15 offen sc1
  s_add_u32 s15, s18, 33792
  s_waitcnt lgkmcnt(11)
  buffer_store_dwordx4 v[68:71], v2, s[36:39], s15 offen sc1
  s_add_u32 s15, s16, 65536
  s_waitcnt lgkmcnt(10)
  buffer_store_dwordx4 v[72:75], v2, s[36:39], s15 offen sc1
  s_waitcnt lgkmcnt(0)
  s_barrier
  ds_read_b128 v[96:99], v3 offset:20480
  ds_read_b128 v[100:103], v3 offset:21504
  ds_read_b128 v[104:107], v3 offset:22528
  ds_read_b128 v[108:111], v3 offset:23552
  ds_read_b128 v[112:115], v3 offset:24576
  v_cvt_pk_bf16_f32 v40, v160, v161
  v_cvt_pk_bf16_f32 v41, v162, v163
  ds_write_b64 v32, v[40:41] offset:40960
  v_cvt_pk_bf16_f32 v42, v164, v165
  v_cvt_pk_bf16_f32 v43, v166, v167
  ds_write_b64 v32, v[42:43] offset:41600
  v_cvt_pk_bf16_f32 v44, v168, v169
  v_cvt_pk_bf16_f32 v45, v170, v171
  ds_write_b64 v33, v[44:45] offset:40960
  v_cvt_pk_bf16_f32 v46, v172, v173
  v_cvt_pk_bf16_f32 v47, v174, v175
  ds_write_b64 v33, v[46:47] offset:41600
  v_cvt_pk_bf16_f32 v40, v176, v177
  v_cvt_pk_bf16_f32 v41, v178, v179
  ds_write_b64 v34, v[40:41] offset:40960
  v_cvt_pk_bf16_f32 v42, v180, v181
  v_cvt_pk_bf16_f32 v43, v182, v183
  ds_write_b64 v34, v[42:43] offset:41600
  v_cvt_pk_bf16_f32 v44, v184, v185
  v_cvt_pk_bf16_f32 v45, v186, v187
  ds_write_b64 v35, v[44:45] offset:40960
  v_cvt_pk_bf16_f32 v46, v188, v189
  v_cvt_pk_bf16_f32 v47, v190, v191
  ds_write_b64 v35, v[46:47] offset:41600
  v_cvt_pk_bf16_f32 v40, v208, v209
  v_cvt_pk_bf16_f32 v41, v210, v211
  ds_write_b64 v36, v[40:41] offset:40960
  v_cvt_pk_bf16_f32 v42, v212, v213
  v_cvt_pk_bf16_f32 v43, v214, v215
  ds_write_b64 v36, v[42:43] offset:41600
  s_mul_i32 s14, s23, 3
  s_add_u32 s14, s14, 1
  s_and_b32 s15, s14, 7
  s_lshl_b32 s15, s15, 2
  s_add_u32 s15, s15, s20
  s_mul_i32 s18, s15, 163840
  s_mul_i32 s19, s22, 5120
  s_add_u32 s18, s18, s19
  s_add_u32 s18, s18, s17
  s_add_u32 s15, s18, 2703360
  s_waitcnt lgkmcnt(14)
  buffer_store_dwordx4 v[96:99], v2, s[36:39], s15 offen sc1
  s_add_u32 s15, s18, 2704384
  s_waitcnt lgkmcnt(13)
  buffer_store_dwordx4 v[100:103], v2, s[36:39], s15 offen sc1
  s_add_u32 s15, s18, 2705408
  s_waitcnt lgkmcnt(12)
  buffer_store_dwordx4 v[104:107], v2, s[36:39], s15 offen sc1
  s_add_u32 s15, s18, 2706432
  s_waitcnt lgkmcnt(11)
  buffer_store_dwordx4 v[108:111], v2, s[36:39], s15 offen sc1
  s_add_u32 s15, s18, 2707456
  s_waitcnt lgkmcnt(10)
  buffer_store_dwordx4 v[112:115], v2, s[36:39], s15 offen sc1
  s_waitcnt lgkmcnt(0)
  s_barrier
  ds_read_b128 v[128:131], v3 offset:40960
  ds_read_b128 v[132:135], v3 offset:41984
  ds_read_b128 v[136:139], v3 offset:43008
  ds_read_b128 v[140:143], v3 offset:44032
  ds_read_b128 v[144:147], v3 offset:45056
  s_mul_i32 s14, s23, 3
  s_add_u32 s14, s14, 2
  s_and_b32 s15, s14, 7
  s_lshl_b32 s15, s15, 2
  s_add_u32 s15, s15, s20
  s_mul_i32 s18, s15, 163840
  s_mul_i32 s19, s22, 5120
  s_add_u32 s18, s18, s19
  s_add_u32 s18, s18, s17
  s_add_u32 s15, s18, 2703360
  s_waitcnt lgkmcnt(4)
  buffer_store_dwordx4 v[128:131], v2, s[36:39], s15 offen sc1
  s_add_u32 s15, s18, 2704384
  s_waitcnt lgkmcnt(3)
  buffer_store_dwordx4 v[132:135], v2, s[36:39], s15 offen sc1
  s_add_u32 s15, s18, 2705408
  s_waitcnt lgkmcnt(2)
  buffer_store_dwordx4 v[136:139], v2, s[36:39], s15 offen sc1
  s_add_u32 s15, s18, 2706432
  s_waitcnt lgkmcnt(1)
  buffer_store_dwordx4 v[140:143], v2, s[36:39], s15 offen sc1
  s_add_u32 s15, s18, 2707456
  s_waitcnt lgkmcnt(0)
  buffer_store_dwordx4 v[144:147], v2, s[36:39], s15 offen sc1
  s_endpgm
k1_kernel_vd:
.p2align 6
k1_kernel_loop_d:
  ds_read_b128 v[40:43], v16 offset:0
  ds_read_b128 v[44:47], v16 offset:2048
  v_mfma_f32_16x16x32_bf16 v[200:203], v[56:59], v[80:83], v[200:203]
  ds_read_b128 v[48:51], v18 offset:0
  ds_read_b128 v[52:55], v18 offset:2048
  v_mfma_f32_16x16x32_bf16 v[204:207], v[60:63], v[80:83], v[204:207]
  ds_read_b64_tr_b16 v[72:73], v20 offset:0
  ds_read_b64_tr_b16 v[74:75], v20 offset:4352
  v_mfma_f32_16x16x32_bf16 v[160:163], v[56:59], v[84:87], v[160:163]
  ds_read_b64_tr_b16 v[76:77], v20 offset:32
  ds_read_b64_tr_b16 v[78:79], v20 offset:4384
  v_mfma_f32_16x16x32_bf16 v[164:167], v[60:63], v[84:87], v[164:167]
  ds_read_b64_tr_b16 v[80:81], v21 offset:64
  ds_read_b64_tr_b16 v[82:83], v21 offset:4416
  v_mfma_f32_16x16x32_bf16 v[168:171], v[64:67], v[84:87], v[168:171]
  v_mfma_f32_16x16x32_bf16 v[172:175], v[68:71], v[84:87], v[172:175]
  v_mfma_f32_16x16x32_bf16 v[176:179], v[56:59], v[88:91], v[176:179]
  v_mfma_f32_16x16x32_bf16 v[180:183], v[60:63], v[88:91], v[180:183]
  v_mfma_f32_16x16x32_bf16 v[184:187], v[64:67], v[88:91], v[184:187]
  v_mfma_f32_16x16x32_bf16 v[188:191], v[68:71], v[88:91], v[188:191]
  v_mfma_f32_16x16x32_bf16 v[208:211], v[56:59], v[92:95], v[208:211]
  v_mfma_f32_16x16x32_bf16 v[212:215], v[60:63], v[92:95], v[212:215]
  ds_read_b128 v[56:59], v17 offset:0
  s_waitcnt lgkmcnt(5)
  v_mfma_f32_16x16x32_bf16 v[96:99], v[40:43], v[72:75], v[96:99]
  ds_read_b128 v[60:63], v17 offset:2048
  ds_read_b128 v[64:67], v19 offset:0
  v_mfma_f32_16x16x32_bf16 v[100:103], v[44:47], v[72:75], v[100:103]
  ds_read_b128 v[68:71], v19 offset:2048
  ds_read_b64_tr_b16 v[84:85], v20 offset:160
  v_mfma_f32_16x16x32_bf16 v[104:107], v[48:51], v[72:75], v[104:107]
  ds_read_b64_tr_b16 v[86:87], v20 offset:4512
  ds_read_b64_tr_b16 v[88:89], v20 offset:192
  v_mfma_f32_16x16x32_bf16 v[108:111], v[52:55], v[72:75], v[108:111]
  ds_read_b64_tr_b16 v[90:91], v20 offset:4544
  s_waitcnt lgkmcnt(10)
  v_mfma_f32_16x16x32_bf16 v[112:115], v[40:43], v[76:79], v[112:115]
  ds_read_b64_tr_b16 v[92:93], v21 offset:224
  ds_read_b64_tr_b16 v[94:95], v21 offset:4576
  v_mfma_f32_16x16x32_bf16 v[116:119], v[44:47], v[76:79], v[116:119]
  ds_read_b64_tr_b16 v[72:73], v20 offset:320
  ds_read_b64_tr_b16 v[74:75], v20 offset:4672
  v_mfma_f32_16x16x32_bf16 v[120:123], v[48:51], v[76:79], v[120:123]
  v_mfma_f32_16x16x32_bf16 v[124:127], v[52:55], v[76:79], v[124:127]
  ds_read_b64_tr_b16 v[76:77], v20 offset:352
  s_waitcnt lgkmcnt(13)
  v_mfma_f32_16x16x32_bf16 v[192:195], v[40:43], v[80:83], v[192:195]
  ds_read_b64_tr_b16 v[78:79], v20 offset:4704
  s_add_u32 s43, s43, 1
  v_mfma_f32_16x16x32_bf16 v[196:199], v[44:47], v[80:83], v[196:199]
  ds_read_b64_tr_b16 v[80:81], v21 offset:384
  s_waitcnt lgkmcnt(9)
  v_mfma_f32_16x16x32_bf16 v[128:131], v[40:43], v[84:87], v[128:131]
  ds_read_b64_tr_b16 v[82:83], v21 offset:4736
  s_cmp_eq_u32 s43, 3
  v_mfma_f32_16x16x32_bf16 v[132:135], v[44:47], v[84:87], v[132:135]
  s_cselect_b32 s43, 0, s43
  s_cselect_b32 s45, s53, s52
  v_mfma_f32_16x16x32_bf16 v[136:139], v[48:51], v[84:87], v[136:139]
  s_cselect_b32 s46, s55, s54
  v_mfma_f32_16x16x32_bf16 v[140:143], v[52:55], v[84:87], v[140:143]
  ds_read_b64_tr_b16 v[84:85], v20 offset:17408
  s_waitcnt lgkmcnt(9)
  v_mfma_f32_16x16x32_bf16 v[144:147], v[40:43], v[88:91], v[144:147]
  ds_read_b64_tr_b16 v[86:87], v20 offset:21760
  v_mfma_f32_16x16x32_bf16 v[148:151], v[44:47], v[88:91], v[148:151]
  v_mfma_f32_16x16x32_bf16 v[152:155], v[48:51], v[88:91], v[152:155]
  v_mfma_f32_16x16x32_bf16 v[156:159], v[52:55], v[88:91], v[156:159]
  ds_read_b64_tr_b16 v[88:89], v20 offset:17440
  s_waitcnt lgkmcnt(9)
  v_mfma_f32_16x16x32_bf16 v[200:203], v[40:43], v[92:95], v[200:203]
  ds_read_b64_tr_b16 v[90:91], v20 offset:21792
  v_add_u32 v16, s45, v16
  v_mfma_f32_16x16x32_bf16 v[204:207], v[44:47], v[92:95], v[204:207]
  ds_read_b64_tr_b16 v[92:93], v21 offset:17472
  s_waitcnt lgkmcnt(9)
  v_mfma_f32_16x16x32_bf16 v[160:163], v[40:43], v[72:75], v[160:163]
  ds_read_b64_tr_b16 v[94:95], v21 offset:21824
  v_add_u32 v17, s45, v17
  v_mfma_f32_16x16x32_bf16 v[164:167], v[44:47], v[72:75], v[164:167]
  v_add_u32 v18, s45, v18
  v_add_u32 v19, s45, v19
  v_mfma_f32_16x16x32_bf16 v[168:171], v[48:51], v[72:75], v[168:171]
  v_mfma_f32_16x16x32_bf16 v[172:175], v[52:55], v[72:75], v[172:175]
  ds_read_b64_tr_b16 v[72:73], v20 offset:17568
  s_waitcnt lgkmcnt(9)
  v_mfma_f32_16x16x32_bf16 v[176:179], v[40:43], v[76:79], v[176:179]
  ds_read_b64_tr_b16 v[74:75], v20 offset:21920
  v_mfma_f32_16x16x32_bf16 v[180:183], v[44:47], v[76:79], v[180:183]
  v_mfma_f32_16x16x32_bf16 v[184:187], v[48:51], v[76:79], v[184:187]
  v_mfma_f32_16x16x32_bf16 v[188:191], v[52:55], v[76:79], v[188:191]
  ds_read_b64_tr_b16 v[76:77], v20 offset:17600
  s_waitcnt lgkmcnt(9)
  v_mfma_f32_16x16x32_bf16 v[208:211], v[40:43], v[80:83], v[208:211]
  ds_read_b64_tr_b16 v[78:79], v20 offset:21952
  v_mfma_f32_16x16x32_bf16 v[212:215], v[44:47], v[80:83], v[212:215]
  ds_read_b64_tr_b16 v[80:81], v21 offset:17632
  s_waitcnt lgkmcnt(9)
  v_mfma_f32_16x16x32_bf16 v[96:99], v[56:59], v[84:87], v[96:99]
  ds_read_b64_tr_b16 v[82:83], v21 offset:21984
  v_mfma_f32_16x16x32_bf16 v[100:103], v[60:63], v[84:87], v[100:103]
  v_mfma_f32_16x16x32_bf16 v[104:107], v[64:67], v[84:87], v[104:107]
  v_mfma_f32_16x16x32_bf16 v[108:111], v[68:71], v[84:87], v[108:111]
  ds_read_b64_tr_b16 v[84:85], v20 offset:17728
  s_waitcnt lgkmcnt(9)
  v_mfma_f32_16x16x32_bf16 v[112:115], v[56:59], v[88:91], v[112:115]
  ds_read_b64_tr_b16 v[86:87], v20 offset:22080
  s_add_u32 s42, s42, 1
  v_mfma_f32_16x16x32_bf16 v[116:119], v[60:63], v[88:91], v[116:119]
  v_mfma_f32_16x16x32_bf16 v[120:123], v[64:67], v[88:91], v[120:123]
  v_mfma_f32_16x16x32_bf16 v[124:127], v[68:71], v[88:91], v[124:127]
  ds_read_b64_tr_b16 v[88:89], v20 offset:17760
  s_waitcnt lgkmcnt(9)
  v_mfma_f32_16x16x32_bf16 v[192:195], v[56:59], v[92:95], v[192:195]
  ds_read_b64_tr_b16 v[90:91], v20 offset:22112
  v_mfma_f32_16x16x32_bf16 v[196:199], v[60:63], v[92:95], v[196:199]
  ds_read_b64_tr_b16 v[92:93], v21 offset:17792
  s_waitcnt lgkmcnt(9)
  v_mfma_f32_16x16x32_bf16 v[128:131], v[56:59], v[72:75], v[128:131]
  ds_read_b64_tr_b16 v[94:95], v21 offset:22144
  v_mfma_f32_16x16x32_bf16 v[132:135], v[60:63], v[72:75], v[132:135]
  v_mfma_f32_16x16x32_bf16 v[136:139], v[64:67], v[72:75], v[136:139]
  v_mfma_f32_16x16x32_bf16 v[140:143], v[68:71], v[72:75], v[140:143]
  s_waitcnt lgkmcnt(8)
  v_mfma_f32_16x16x32_bf16 v[144:147], v[56:59], v[76:79], v[144:147]
  v_mfma_f32_16x16x32_bf16 v[148:151], v[60:63], v[76:79], v[148:151]
  v_mfma_f32_16x16x32_bf16 v[152:155], v[64:67], v[76:79], v[152:155]
  v_mfma_f32_16x16x32_bf16 v[156:159], v[68:71], v[76:79], v[156:159]
  v_add_u32 v20, s46, v20
  v_add_u32 v21, s46, v21
  s_cmp_lt_u32 s42, 10
  s_waitcnt lgkmcnt(0)
  s_barrier
  s_cbranch_scc1 k1_kernel_loop_d
  v_mfma_f32_16x16x32_bf16 v[200:203], v[56:59], v[80:83], v[200:203]
  v_mfma_f32_16x16x32_bf16 v[204:207], v[60:63], v[80:83], v[204:207]
  v_mfma_f32_16x16x32_bf16 v[160:163], v[56:59], v[84:87], v[160:163]
  v_mfma_f32_16x16x32_bf16 v[164:167], v[60:63], v[84:87], v[164:167]
  v_mfma_f32_16x16x32_bf16 v[168:171], v[64:67], v[84:87], v[168:171]
  v_mfma_f32_16x16x32_bf16 v[172:175], v[68:71], v[84:87], v[172:175]
  v_mfma_f32_16x16x32_bf16 v[176:179], v[56:59], v[88:91], v[176:179]
  v_mfma_f32_16x16x32_bf16 v[180:183], v[60:63], v[88:91], v[180:183]
  v_mfma_f32_16x16x32_bf16 v[184:187], v[64:67], v[88:91], v[184:187]
  v_mfma_f32_16x16x32_bf16 v[188:191], v[68:71], v[88:91], v[188:191]
  v_mfma_f32_16x16x32_bf16 v[208:211], v[56:59], v[92:95], v[208:211]
  v_mfma_f32_16x16x32_bf16 v[212:215], v[60:63], v[92:95], v[212:215]
  s_waitcnt vmcnt(0)
  s_barrier
  s_mul_i32 s17, s21, 8388608
  s_mul_i32 s18, s20, 5120
  v_lshlrev_b32 v2, 4, v1
  v_add_u32 v3, s18, v2
  v_cvt_pk_bf16_f32 v40, v96, v97
  v_cvt_pk_bf16_f32 v41, v98, v99
  ds_write_b64 v32, v[40:41] offset:0
  v_cvt_pk_bf16_f32 v42, v100, v101
  v_cvt_pk_bf16_f32 v43, v102, v103
  ds_write_b64 v32, v[42:43] offset:640
  v_cvt_pk_bf16_f32 v44, v104, v105
  v_cvt_pk_bf16_f32 v45, v106, v107
  ds_write_b64 v33, v[44:45] offset:0
  v_cvt_pk_bf16_f32 v46, v108, v109
  v_cvt_pk_bf16_f32 v47, v110, v111
  ds_write_b64 v33, v[46:47] offset:640
  v_cvt_pk_bf16_f32 v40, v112, v113
  v_cvt_pk_bf16_f32 v41, v114, v115
  ds_write_b64 v34, v[40:41] offset:0
  v_cvt_pk_bf16_f32 v42, v116, v117
  v_cvt_pk_bf16_f32 v43, v118, v119
  ds_write_b64 v34, v[42:43] offset:640
  v_cvt_pk_bf16_f32 v44, v120, v121
  v_cvt_pk_bf16_f32 v45, v122, v123
  ds_write_b64 v35, v[44:45] offset:0
  v_cvt_pk_bf16_f32 v46, v124, v125
  v_cvt_pk_bf16_f32 v47, v126, v127
  ds_write_b64 v35, v[46:47] offset:640
  v_cvt_pk_bf16_f32 v40, v192, v193
  v_cvt_pk_bf16_f32 v41, v194, v195
  ds_write_b64 v36, v[40:41] offset:0
  v_cvt_pk_bf16_f32 v42, v196, v197
  v_cvt_pk_bf16_f32 v43, v198, v199
  ds_write_b64 v36, v[42:43] offset:640
  s_waitcnt lgkmcnt(0)
  s_barrier
  ds_read_b128 v[56:59], v3 offset:0
  ds_read_b128 v[60:63], v3 offset:1024
  ds_read_b128 v[64:67], v3 offset:2048
  ds_read_b128 v[68:71], v3 offset:3072
  ds_read_b128 v[72:75], v3 offset:4096
  v_cvt_pk_bf16_f32 v40, v128, v129
  v_cvt_pk_bf16_f32 v41, v130, v131
  ds_write_b64 v32, v[40:41] offset:20480
  v_cvt_pk_bf16_f32 v42, v132, v133
  v_cvt_pk_bf16_f32 v43, v134, v135
  ds_write_b64 v32, v[42:43] offset:21120
  v_cvt_pk_bf16_f32 v44, v136, v137
  v_cvt_pk_bf16_f32 v45, v138, v139
  ds_write_b64 v33, v[44:45] offset:20480
  v_cvt_pk_bf16_f32 v46, v140, v141
  v_cvt_pk_bf16_f32 v47, v142, v143
  ds_write_b64 v33, v[46:47] offset:21120
  v_cvt_pk_bf16_f32 v40, v144, v145
  v_cvt_pk_bf16_f32 v41, v146, v147
  ds_write_b64 v34, v[40:41] offset:20480
  v_cvt_pk_bf16_f32 v42, v148, v149
  v_cvt_pk_bf16_f32 v43, v150, v151
  ds_write_b64 v34, v[42:43] offset:21120
  v_cvt_pk_bf16_f32 v44, v152, v153
  v_cvt_pk_bf16_f32 v45, v154, v155
  ds_write_b64 v35, v[44:45] offset:20480
  v_cvt_pk_bf16_f32 v46, v156, v157
  v_cvt_pk_bf16_f32 v47, v158, v159
  ds_write_b64 v35, v[46:47] offset:21120
  v_cvt_pk_bf16_f32 v40, v200, v201
  v_cvt_pk_bf16_f32 v41, v202, v203
  ds_write_b64 v36, v[40:41] offset:20480
  v_cvt_pk_bf16_f32 v42, v204, v205
  v_cvt_pk_bf16_f32 v43, v206, v207
  ds_write_b64 v36, v[42:43] offset:21120
  s_mul_i32 s14, s23, 3
  s_add_u32 s14, s14, 0
  s_and_b32 s15, s14, 7
  s_lshl_b32 s15, s15, 2
  s_add_u32 s15, s15, s20
  s_mul_i32 s18, s15, 163840
  s_mul_i32 s19, s22, 5120
  s_add_u32 s18, s18, s19
  s_add_u32 s18, s18, s17
  s_add_u32 s15, s18, 2703360
  s_waitcnt lgkmcnt(14)
  buffer_store_dwordx4 v[56:59], v2, s[36:39], s15 offen sc1
  s_add_u32 s15, s18, 2704384
  s_waitcnt lgkmcnt(13)
  buffer_store_dwordx4 v[60:63], v2, s[36:39], s15 offen sc1
  s_add_u32 s15, s18, 2705408
  s_waitcnt lgkmcnt(12)
  buffer_store_dwordx4 v[64:67], v2, s[36:39], s15 offen sc1
  s_add_u32 s15, s18, 2706432
  s_waitcnt lgkmcnt(11)
  buffer_store_dwordx4 v[68:71], v2, s[36:39], s15 offen sc1
  s_add_u32 s15, s18, 2707456
  s_waitcnt lgkmcnt(10)
  buffer_store_dwordx4 v[72:75], v2, s[36:39], s15 offen sc1
  s_waitcnt lgkmcnt(0)
  s_barrier
  ds_read_b128 v[96:99], v3 offset:20480
  ds_read_b128 v[100:103], v3 offset:21504
  ds_read_b128 v[104:107], v3 offset:22528
  ds_read_b128 v[108:111], v3 offset:23552
  ds_read_b128 v[112:115], v3 offset:24576
  v_cvt_pk_bf16_f32 v40, v160, v161
  v_cvt_pk_bf16_f32 v41, v162, v163
  ds_write_b64 v32, v[40:41] offset:40960
  v_cvt_pk_bf16_f32 v42, v164, v165
  v_cvt_pk_bf16_f32 v43, v166, v167
  ds_write_b64 v32, v[42:43] offset:41600
  v_cvt_pk_bf16_f32 v44, v168, v169
  v_cvt_pk_bf16_f32 v45, v170, v171
  ds_write_b64 v33, v[44:45] offset:40960
  v_cvt_pk_bf16_f32 v46, v172, v173
  v_cvt_pk_bf16_f32 v47, v174, v175
  ds_write_b64 v33, v[46:47] offset:41600
  v_cvt_pk_bf16_f32 v40, v176, v177
  v_cvt_pk_bf16_f32 v41, v178, v179
  ds_write_b64 v34, v[40:41] offset:40960
  v_cvt_pk_bf16_f32 v42, v180, v181
  v_cvt_pk_bf16_f32 v43, v182, v183
  ds_write_b64 v34, v[42:43] offset:41600
  v_cvt_pk_bf16_f32 v44, v184, v185
  v_cvt_pk_bf16_f32 v45, v186, v187
  ds_write_b64 v35, v[44:45] offset:40960
  v_cvt_pk_bf16_f32 v46, v188, v189
  v_cvt_pk_bf16_f32 v47, v190, v191
  ds_write_b64 v35, v[46:47] offset:41600
  v_cvt_pk_bf16_f32 v40, v208, v209
  v_cvt_pk_bf16_f32 v41, v210, v211
  ds_write_b64 v36, v[40:41] offset:40960
  v_cvt_pk_bf16_f32 v42, v212, v213
  v_cvt_pk_bf16_f32 v43, v214, v215
  ds_write_b64 v36, v[42:43] offset:41600
  s_mul_i32 s14, s23, 3
  s_add_u32 s14, s14, 1
  s_and_b32 s15, s14, 7
  s_lshl_b32 s15, s15, 2
  s_add_u32 s15, s15, s20
  s_mul_i32 s18, s15, 163840
  s_mul_i32 s19, s22, 5120
  s_add_u32 s18, s18, s19
  s_add_u32 s18, s18, s17
  s_add_u32 s15, s18, 2703360
  s_waitcnt lgkmcnt(14)
  buffer_store_dwordx4 v[96:99], v2, s[36:39], s15 offen sc1
  s_add_u32 s15, s18, 2704384
  s_waitcnt lgkmcnt(13)
  buffer_store_dwordx4 v[100:103], v2, s[36:39], s15 offen sc1
  s_add_u32 s15, s18, 2705408
  s_waitcnt lgkmcnt(12)
  buffer_store_dwordx4 v[104:107], v2, s[36:39], s15 offen sc1
  s_add_u32 s15, s18, 2706432
  s_waitcnt lgkmcnt(11)
  buffer_store_dwordx4 v[108:111], v2, s[36:39], s15 offen sc1
  s_add_u32 s15, s18, 2707456
  s_waitcnt lgkmcnt(10)
  buffer_store_dwordx4 v[112:115], v2, s[36:39], s15 offen sc1
  s_waitcnt lgkmcnt(0)
  s_barrier
  ds_read_b128 v[128:131], v3 offset:40960
  ds_read_b128 v[132:135], v3 offset:41984
  ds_read_b128 v[136:139], v3 offset:43008
  ds_read_b128 v[140:143], v3 offset:44032
  ds_read_b128 v[144:147], v3 offset:45056
  s_mul_i32 s14, s23, 3
  s_add_u32 s14, s14, 2
  s_and_b32 s15, s14, 7
  s_lshl_b32 s15, s15, 2
  s_add_u32 s15, s15, s20
  s_mul_i32 s18, s15, 163840
  s_mul_i32 s19, s22, 5120
  s_add_u32 s18, s18, s19
  s_add_u32 s18, s18, s17
  s_add_u32 s15, s18, 2703360
  s_waitcnt lgkmcnt(4)
  buffer_store_dwordx4 v[128:131], v2, s[36:39], s15 offen sc1
  s_add_u32 s15, s18, 2704384
  s_waitcnt lgkmcnt(3)
  buffer_store_dwordx4 v[132:135], v2, s[36:39], s15 offen sc1
  s_add_u32 s15, s18, 2705408
  s_waitcnt lgkmcnt(2)
  buffer_store_dwordx4 v[136:139], v2, s[36:39], s15 offen sc1
  s_add_u32 s15, s18, 2706432
  s_waitcnt lgkmcnt(1)
  buffer_store_dwordx4 v[140:143], v2, s[36:39], s15 offen sc1
  s_add_u32 s15, s18, 2707456
  s_waitcnt lgkmcnt(0)
  buffer_store_dwordx4 v[144:147], v2, s[36:39], s15 offen sc1
  s_endpgm
k1_kernel_loader:
  s_sub_u32 s20, s20, 4
  v_lshrrev_b32 v2, 3, v1
  v_and_b32 v3, 7, v1
  v_xor_b32 v3, v3, v2
  s_lshl_b32 s16, s22, 7
  s_lshl_b32 s17, s20, 5
  s_add_u32 s16, s16, s17
  v_add_u32 v2, s16, v2
  v_mul_u32_u24 v8, 1280, v2
  v_lshl_add_u32 v8, v3, 4, v8
  v_add_u32 v9, 9216, v8
  v_add_u32 v10, 18432, v8
  v_add_u32 v11, 27648, v8
  v_cmp_lt_u32 vcc, 29, v1
  s_lshl_b32 s16, s20, 4
  s_mul_i32 s16, s16, 3840
  s_mul_i32 s17, s23, 480
  s_add_u32 s16, s16, s17
  v_lshlrev_b32 v2, 4, v1
  v_mov_b32 v3, 3360
  v_cndmask_b32 v3, 0, v3, vcc
  v_add3_u32 v2, v2, v3, s16
  v_cmp_gt_u32 vcc, 60, v1
  v_mov_b32 v3, 0x40000000
  s_nop 0
  v_cndmask_b32 v12, v3, v2, vcc
  v_add_u32 v13, 6592, v12
  v_add_u32 v14, 28544, v12
  v_add_u32 v15, 35136, v12
  s_lshl_b32 s48, s20, 12
  s_mul_i32 s49, s20, 8704
  s_add_u32 s49, s49, 49152
  s_and_b32 s16, s22, 7
  s_mul_i32 s16, s16, 1
  s_and_b32 s17, s23, 3
  s_mul_i32 s17, s17, 1
  s_add_u32 s26, s16, s17
  s_and_b32 s26, s26, 1
  s_mul_i32 s26, s26, 3
  s_mov_b32 s30, 0x280000
  s_mov_b32 s31, 0x00020000
  s_mov_b32 s34, 0x258000
  s_mov_b32 s35, 0x00020000
  s_lshl_b32 s40, s26, 7
  s_mul_i32 s41, s26, 245760
  s_add_u32 s44, s41, 15360
  s_mov_b32 m0, s48
  s_add_u32 s26, s26, 1
  s_cmp_eq_u32 s26, 10
  s_cselect_b32 s26, 0, s26
  s_cmp_eq_u32 s21, 0
  s_waitcnt lgkmcnt(0)
  s_cselect_b32 s28, s4, s8
  s_cselect_b32 s29, s5, s9
  s_cselect_b32 s32, s6, s10
  s_cselect_b32 s33, s7, s11
  buffer_load_dwordx4 v8, s[28:31], s40 offen offset:0  lds
  buffer_load_dwordx4 v9, s[28:31], s40 offen offset:1024  lds
  buffer_load_dwordx4 v10, s[28:31], s40 offen offset:2048  lds
  buffer_load_dwordx4 v11, s[28:31], s40 offen offset:3072  lds
  s_add_u32 m0, s49, 0
  s_nop 0
  buffer_load_dwordx4 v12, s[32:35], s41 offen offset:0  lds
  buffer_load_dwordx4 v13, s[32:35], s41 offen offset:1088  lds
  buffer_load_dwordx4 v14, s[32:35], s41 offen offset:2176  lds
  buffer_load_dwordx4 v15, s[32:35], s41 offen offset:3264  lds
  s_add_u32 m0, m0, 4352
  s_nop 0
  buffer_load_dwordx4 v12, s[32:35], s44 offen offset:0  lds
  buffer_load_dwordx4 v13, s[32:35], s44 offen offset:1088  lds
  buffer_load_dwordx4 v14, s[32:35], s44 offen offset:2176  lds
  buffer_load_dwordx4 v15, s[32:35], s44 offen offset:3264  lds
  s_lshl_b32 s40, s26, 7
  s_mul_i32 s41, s26, 245760
  s_add_u32 s44, s41, 15360
  s_add_u32 m0, s48, 16384
  s_add_u32 s26, s26, 1
  s_cmp_eq_u32 s26, 10
  s_cselect_b32 s26, 0, s26
  buffer_load_dwordx4 v8, s[28:31], s40 offen offset:0  lds
  buffer_load_dwordx4 v9, s[28:31], s40 offen offset:1024  lds
  buffer_load_dwordx4 v10, s[28:31], s40 offen offset:2048  lds
  buffer_load_dwordx4 v11, s[28:31], s40 offen offset:3072  lds
  s_add_u32 m0, s49, 34816
  s_nop 0
  buffer_load_dwordx4 v12, s[32:35], s41 offen offset:0  lds
  buffer_load_dwordx4 v13, s[32:35], s41 offen offset:1088  lds
  buffer_load_dwordx4 v14, s[32:35], s41 offen offset:2176  lds
  buffer_load_dwordx4 v15, s[32:35], s41 offen offset:3264  lds
  s_add_u32 m0, m0, 4352
  s_nop 0
  buffer_load_dwordx4 v12, s[32:35], s44 offen offset:0  lds
  buffer_load_dwordx4 v13, s[32:35], s44 offen offset:1088  lds
  buffer_load_dwordx4 v14, s[32:35], s44 offen offset:2176  lds
  buffer_load_dwordx4 v15, s[32:35], s44 offen offset:3264  lds
  s_mov_b32 s36, s12
  s_mov_b32 s37, s13
  s_mov_b32 s38, 0x10000000
  s_mov_b32 s39, 0x00020000
  s_mov_b32 s42, 0
  s_mov_b32 s43, 2
  s_mov_b32 s52, 16384
  s_mov_b32 s53, 4294934528
  s_mov_b32 s54, 34816
  s_mov_b32 s55, 4294897664
  s_add_u32 s48, s48, 32768
  s_add_u32 s49, s49, 69632
  s_lshl_b32 s40, s26, 7
  s_mul_i32 s41, s26, 245760
  s_add_u32 s44, s41, 15360
  s_waitcnt vmcnt(12)
  s_barrier
.p2align 6
k1_kernel_lloop:
  s_mov_b32 m0, s48
  s_add_u32 s26, s26, 1
  s_cmp_eq_u32 s26, 10
  s_cselect_b32 s26, 0, s26
  buffer_load_dwordx4 v8, s[28:31], s40 offen offset:0  lds
  buffer_load_dwordx4 v9, s[28:31], s40 offen offset:1024  lds
  buffer_load_dwordx4 v10, s[28:31], s40 offen offset:2048  lds
  buffer_load_dwordx4 v11, s[28:31], s40 offen offset:3072  lds
  s_mov_b32 m0, s49
  s_nop 0
  buffer_load_dwordx4 v12, s[32:35], s41 offen offset:0  lds
  buffer_load_dwordx4 v13, s[32:35], s41 offen offset:1088  lds
  buffer_load_dwordx4 v14, s[32:35], s41 offen offset:2176  lds
  buffer_load_dwordx4 v15, s[32:35], s41 offen offset:3264  lds
  s_add_u32 m0, m0, 4352
  s_nop 0
  buffer_load_dwordx4 v12, s[32:35], s44 offen offset:0  lds
  buffer_load_dwordx4 v13, s[32:35], s44 offen offset:1088  lds
  buffer_load_dwordx4 v14, s[32:35], s44 offen offset:2176  lds
  buffer_load_dwordx4 v15, s[32:35], s44 offen offset:3264  lds
  s_lshl_b32 s40, s26, 7
  s_mul_i32 s41, s26, 245760
  s_add_u32 s44, s41, 15360
  s_cmp_eq_u32 s43, 2
  s_cselect_b32 s45, s53, s52
  s_cselect_b32 s46, s55, s54
  s_add_u32 s43, s43, 1
  s_cmp_eq_u32 s43, 3
  s_cselect_b32 s43, 0, s43
  s_add_u32 s48, s48, s45
  s_add_u32 s49, s49, s46
  s_add_u32 s42, s42, 1
  s_cmp_lt_u32 s42, 8
  s_waitcnt vmcnt(12)
  s_barrier
  s_cbranch_scc1 k1_kernel_lloop
  s_waitcnt vmcnt(0)
  s_cmp_eq_u32 s20, 0
  s_cbranch_scc1 k1_kernel_ljob
  s_barrier
  s_endpgm
k1_kernel_ljob:
  s_cmp_lt_u32 s2, 32
  s_cbranch_scc1 k1_kernel_lphi
  s_cmp_gt_u32 s2, 40
  s_cbranch_scc1 k1_kernel_lnone
  s_cmp_eq_u32 s2, 32
  s_cbranch_scc0 k1_kernel_lttab
  v_add_u32 v2, 0, v1
  v_mul_u32_u24 v3, 6554, v2
  v_lshrrev_b32 v3, 16, v3
  v_mul_u32_u24 v4, 10, v3
  v_sub_u32 v4, v2, v4
  v_lshlrev_b32 v4, 4, v4
  v_and_b32 v5, 4, v3
  v_and_b32 v6, 8, v3
  v_and_b32 v3, 0xfffffff3, v3
  v_lshl_or_b32 v3, v5, 1, v3
  v_lshrrev_b32 v6, 1, v6
  v_or_b32 v3, v6, v3
  v_lshrrev_b32 v5, 4, v3
  v_lshl_add_u32 v3, v5, 2, v3
  v_mul_u32_u24 v3, 1280, v3
  v_add_u32 v60, v3, v4
  v_add_u32 v2, 64, v1
  v_mul_u32_u24 v3, 6554, v2
  v_lshrrev_b32 v3, 16, v3
  v_mul_u32_u24 v4, 10, v3
  v_sub_u32 v4, v2, v4
  v_lshlrev_b32 v4, 4, v4
  v_and_b32 v5, 4, v3
  v_and_b32 v6, 8, v3
  v_and_b32 v3, 0xfffffff3, v3
  v_lshl_or_b32 v3, v5, 1, v3
  v_lshrrev_b32 v6, 1, v6
  v_or_b32 v3, v6, v3
  v_lshrrev_b32 v5, 4, v3
  v_lshl_add_u32 v3, v5, 2, v3
  v_mul_u32_u24 v3, 1280, v3
  v_add_u32 v61, v3, v4
  v_subrev_u32 v61, 1024, v61
  v_add_u32 v2, 128, v1
  v_mul_u32_u24 v3, 6554, v2
  v_lshrrev_b32 v3, 16, v3
  v_mul_u32_u24 v4, 10, v3
  v_sub_u32 v4, v2, v4
  v_lshlrev_b32 v4, 4, v4
  v_and_b32 v5, 4, v3
  v_and_b32 v6, 8, v3
  v_and_b32 v3, 0xfffffff3, v3
  v_lshl_or_b32 v3, v5, 1, v3
  v_lshrrev_b32 v6, 1, v6
  v_or_b32 v3, v6, v3
  v_lshrrev_b32 v5, 4, v3
  v_lshl_add_u32 v3, v5, 2, v3
  v_mul_u32_u24 v3, 1280, v3
  v_add_u32 v62, v3, v4
  v_subrev_u32 v62, 2048, v62
  v_add_u32 v2, 192, v1
  v_mul_u32_u24 v3, 6554, v2
  v_lshrrev_b32 v3, 16, v3
  v_mul_u32_u24 v4, 10, v3
  v_sub_u32 v4, v2, v4
  v_lshlrev_b32 v4, 4, v4
  v_and_b32 v5, 4, v3
  v_and_b32 v6, 8, v3
  v_and_b32 v3, 0xfffffff3, v3
  v_lshl_or_b32 v3, v5, 1, v3
  s_barrier
  v_lshrrev_b32 v6, 1, v6
  v_or_b32 v3, v6, v3
  v_lshrrev_b32 v5, 4, v3
  v_lshl_add_u32 v3, v5, 2, v3
  v_mul_u32_u24 v3, 1280, v3
  v_add_u32 v63, v3, v4
  v_subrev_u32 v63, 3072, v63
  v_add_u32 v2, 256, v1
  v_mul_u32_u24 v3, 6554, v2
  v_lshrrev_b32 v3, 16, v3
  v_mul_u32_u24 v4, 10, v3
  v_sub_u32 v4, v2, v4
  v_lshlrev_b32 v4, 4, v4
  v_and_b32 v5, 4, v3
  v_and_b32 v6, 8, v3
  v_and_b32 v3, 0xfffffff3, v3
  v_lshl_or_b32 v3, v5, 1, v3
  v_lshrrev_b32 v6, 1, v6
  v_or_b32 v3, v6, v3
  v_lshrrev_b32 v5, 4, v3
  v_lshl_add_u32 v3, v5, 2, v3
  v_mul_u32_u24 v3, 1280, v3
  v_add_u32 v64, v3, v4
  v_add_u32 v2, 0, v1
  v_mul_u32_u24 v3, 6554, v2
  v_lshrrev_b32 v3, 16, v3
  v_mul_u32_u24 v4, 10, v3
  v_sub_u32 v4, v2, v4
  v_lshlrev_b32 v4, 4, v4
  v_mul_u32_u24 v72, 2560, v3
  v_add_u32 v72, v72, v4
  v_and_b32 v5, 4, v3
  v_and_b32 v6, 8, v3
  v_and_b32 v3, 0xfffffff3, v3
  v_lshl_or_b32 v3, v5, 1, v3
  v_lshrrev_b32 v6, 1, v6
  v_or_b32 v3, v6, v3
  v_lshrrev_b32 v5, 2, v3
  v_and_b32 v3, 3, v3
  v_mad_u32_u24 v3, v5, 20, v3
  v_add_u32 v3, 16, v3
  v_mul_u32_u24 v3, 1280, v3
  v_add_u32 v65, v3, v4
  v_add_u32 v2, 64, v1
  v_mul_u32_u24 v3, 6554, v2
  v_lshrrev_b32 v3, 16, v3
  v_mul_u32_u24 v4, 10, v3
  v_sub_u32 v4, v2, v4
  s_barrier
  v_lshlrev_b32 v4, 4, v4
  v_mul_u32_u24 v73, 2560, v3
  v_add_u32 v73, v73, v4
  v_and_b32 v5, 4, v3
  v_and_b32 v6, 8, v3
  v_and_b32 v3, 0xfffffff3, v3
  v_lshl_or_b32 v3, v5, 1, v3
  v_lshrrev_b32 v6, 1, v6
  v_or_b32 v3, v6, v3
  v_lshrrev_b32 v5, 2, v3
  v_and_b32 v3, 3, v3
  v_mad_u32_u24 v3, v5, 20, v3
  v_add_u32 v3, 16, v3
  v_mul_u32_u24 v3, 1280, v3
  v_add_u32 v66, v3, v4
  v_subrev_u32 v66, 1024, v66
  v_add_u32 v2, 128, v1
  v_mul_u32_u24 v3, 6554, v2
  v_lshrrev_b32 v3, 16, v3
  v_mul_u32_u24 v4, 10, v3
  v_sub_u32 v4, v2, v4
  v_lshlrev_b32 v4, 4, v4
  v_mul_u32_u24 v74, 2560, v3
  v_add_u32 v74, v74, v4
  v_and_b32 v5, 4, v3
  v_and_b32 v6, 8, v3
  v_and_b32 v3, 0xfffffff3, v3
  v_lshl_or_b32 v3, v5, 1, v3
  v_lshrrev_b32 v6, 1, v6
  v_or_b32 v3, v6, v3
  v_lshrrev_b32 v5, 2, v3
  v_and_b32 v3, 3, v3
  v_mad_u32_u24 v3, v5, 20, v3
  v_add_u32 v3, 16, v3
  v_mul_u32_u24 v3, 1280, v3
  v_add_u32 v67, v3, v4
  v_subrev_u32 v67, 2048, v67
  v_add_u32 v2, 192, v1
  v_mul_u32_u24 v3, 6554, v2
  v_lshrrev_b32 v3, 16, v3
  v_mul_u32_u24 v4, 10, v3
  v_sub_u32 v4, v2, v4
  v_lshlrev_b32 v4, 4, v4
  v_mul_u32_u24 v75, 2560, v3
  v_add_u32 v75, v75, v4
  v_and_b32 v5, 4, v3
  v_and_b32 v6, 8, v3
  v_and_b32 v3, 0xfffffff3, v3
  s_barrier
  v_lshl_or_b32 v3, v5, 1, v3
  v_lshrrev_b32 v6, 1, v6
  v_or_b32 v3, v6, v3
  v_lshrrev_b32 v5, 2, v3
  v_and_b32 v3, 3, v3
  v_mad_u32_u24 v3, v5, 20, v3
  v_add_u32 v3, 16, v3
  v_mul_u32_u24 v3, 1280, v3
  v_add_u32 v68, v3, v4
  v_subrev_u32 v68, 3072, v68
  v_add_u32 v2, 256, v1
  v_mul_u32_u24 v3, 6554, v2
  v_lshrrev_b32 v3, 16, v3
  v_mul_u32_u24 v4, 10, v3
  v_sub_u32 v4, v2, v4
  v_lshlrev_b32 v4, 4, v4
  v_mul_u32_u24 v76, 2560, v3
  v_add_u32 v76, v76, v4
  v_and_b32 v5, 4, v3
  v_and_b32 v6, 8, v3
  v_and_b32 v3, 0xfffffff3, v3
  v_lshl_or_b32 v3, v5, 1, v3
  v_lshrrev_b32 v6, 1, v6
  v_or_b32 v3, v6, v3
  v_lshrrev_b32 v5, 2, v3
  v_and_b32 v3, 3, v3
  v_mad_u32_u24 v3, v5, 20, v3
  v_add_u32 v3, 16, v3
  v_mul_u32_u24 v3, 1280, v3
  v_add_u32 v69, v3, v4
  v_and_b32 v2, 15, v1
  v_lshrrev_b32 v3, 4, v1
  v_mul_u32_u24 v4, 33024, v3
  v_lshl_add_u32 v70, v2, 4, v4
  v_mul_u32_u24 v4, 33280, v3
  v_lshl_add_u32 v71, v2, 3, v4
  v_lshrrev_b32 v5, 1, v3
  v_lshlrev_b32 v5, 4, v5
  v_and_b32 v6, 1, v3
  v_lshl_add_u32 v5, v6, 2, v5
  v_lshrrev_b32 v6, 2, v2
  v_add_u32 v5, v5, v6
  v_mul_u32_u24 v5, 160, v5
  v_and_b32 v6, 3, v2
  v_lshl_add_u32 v77, v6, 3, v5
  v_add_u32 v77, 40960, v77
  v_mul_u32_u24 v5, 160, v2
  v_lshl_add_u32 v78, v3, 3, v5
  s_barrier
  v_mov_b32 v79, 0
  v_and_b32 v6, 31, v1
  v_lshrrev_b32 v7, 5, v1
  v_mul_u32_u24 v4, 80, v6
  v_mad_u32_u24 v80, v7, 40, v4
  v_lshrrev_b32 v4, 1, v3
  v_lshlrev_b32 v4, 3, v4
  v_lshrrev_b32 v5, 2, v2
  v_add_u32 v4, v4, v5
  v_mul_u32_u24 v4, 80, v4
  v_and_b32 v3, 1, v3
  v_lshlrev_b32 v3, 5, v3
  v_and_b32 v2, 3, v2
  v_lshl_add_u32 v3, v2, 3, v3
  v_add_u32 v81, v4, v3
  v_lshlrev_b32 v2, 9, v7
  v_lshl_add_u32 v82, v6, 2, v2
  v_lshlrev_b32 v3, 7, v7
  v_lshl_add_u32 v83, v6, 2, v3
  s_barrier
  v_lshlrev_b32 v2, 4, v1
  s_mov_b32 s14, 22937600
  buffer_store_dwordx4 v[60:63], v2, s[36:39], s14 offen
  s_add_u32 s14, s14, 1024
  buffer_store_dwordx4 v[64:67], v2, s[36:39], s14 offen
  s_add_u32 s14, s14, 1024
  buffer_store_dwordx4 v[68:71], v2, s[36:39], s14 offen
  s_add_u32 s14, s14, 1024
  buffer_store_dwordx4 v[72:75], v2, s[36:39], s14 offen
  s_add_u32 s14, s14, 1024
  buffer_store_dwordx4 v[76:79], v2, s[36:39], s14 offen
  s_add_u32 s14, s14, 1024
  buffer_store_dwordx4 v[80:83], v2, s[36:39], s14 offen
  s_lshl_b32 s15, s2, 7
  v_mov_b32 v2, 0
  v_mov_b32 v3, 0
  s_add_u32 s16, s15, 22806528
  s_add_u32 s17, s15, 22872064
  s_mov_b64 exec, 1
  buffer_store_dword v2, v3, s[36:39], s16 offen
  buffer_store_dword v2, v3, s[36:39], s17 offen
  s_mov_b64 exec, -1
  s_endpgm
k1_kernel_lttab:
  s_barrier
  s_sub_u32 s15, s2, 33
  s_lshl_b32 s15, s15, 6
  v_add_u32 v59, s15, v1
  v_add_u32 v2, 0, v59
  v_mul_u32_u24 v3, 1639, v2
  v_lshrrev_b32 v3, 16, v3
  v_mul_u32_u24 v4, 40, v3
  v_sub_u32 v4, v2, v4
  v_mul_u32_u24 v64, 96, v3
  v_lshl_add_u32 v64, v4, 1, v64
  v_cmp_lt_u32 vcc, 19, v4
  v_mov_b32 v5, 8
  s_nop 0
  v_cndmask_b32 v5, 0, v5, vcc
  v_add_u32 v64, v64, v5
  v_lshlrev_b32 v60, 7, v3
  v_lshl_add_u32 v60, v4, 2, v60
  v_lshlrev_b32 v3, 5, v3
  v_lshl_add_u32 v3, v4, 2, v3
  v_add_u32 v3, 2944, v3
  v_cmp_lt_u32 vcc, 31, v4
  v_lshlrev_b32 v62, 2, v2
  v_mov_b32 v5, 0x40000000
  v_cndmask_b32 v60, v60, v3, vcc
  v_cmp_gt_u32 vcc, 840, v2
  v_min_u32 v60, 3836, v60
  v_add_u32 v60, 102400, v60
  v_cndmask_b32 v62, v5, v62, vcc
  v_subrev_u32 v5, 840, v2
  v_lshrrev_b32 v6, 3, v5
  v_mul_u32_u24 v6, 96, v6
  v_bfe_u32 v7, v5, 2, 1
  v_mad_u32_u24 v6, v7, 48, v6
  v_and_b32 v7, 3, v5
  v_lshl_add_u32 v6, v7, 1, v6
  v_add_u32 v6, 40, v6
  v_cndmask_b32 v64, v6, v64, vcc
  v_cmp_lt_u32 vcc, 1007, v2
  v_mov_b32 v5, 3072
  s_nop 0
  v_cndmask_b32 v64, v64, v5, vcc
  v_add_u32 v2, 512, v59
  v_mul_u32_u24 v3, 1639, v2
  v_lshrrev_b32 v3, 16, v3
  v_mul_u32_u24 v4, 40, v3
  v_sub_u32 v4, v2, v4
  v_mul_u32_u24 v65, 96, v3
  v_lshl_add_u32 v65, v4, 1, v65
  s_barrier
  v_cmp_lt_u32 vcc, 19, v4
  v_mov_b32 v5, 8
  s_nop 0
  v_cndmask_b32 v5, 0, v5, vcc
  v_add_u32 v65, v65, v5
  v_lshlrev_b32 v61, 7, v3
  v_lshl_add_u32 v61, v4, 2, v61
  v_lshlrev_b32 v3, 5, v3
  v_lshl_add_u32 v3, v4, 2, v3
  v_add_u32 v3, 2944, v3
  v_cmp_lt_u32 vcc, 31, v4
  v_lshlrev_b32 v63, 2, v2
  v_mov_b32 v5, 0x40000000
  v_cndmask_b32 v61, v61, v3, vcc
  v_cmp_gt_u32 vcc, 840, v2
  v_min_u32 v61, 3836, v61
  v_add_u32 v61, 102400, v61
  v_cndmask_b32 v63, v5, v63, vcc
  v_subrev_u32 v5, 840, v2
  v_lshrrev_b32 v6, 3, v5
  v_mul_u32_u24 v6, 96, v6
  v_bfe_u32 v7, v5, 2, 1
  v_mad_u32_u24 v6, v7, 48, v6
  v_and_b32 v7, 3, v5
  v_lshl_add_u32 v6, v7, 1, v6
  v_add_u32 v6, 40, v6
  v_cndmask_b32 v65, v6, v65, vcc
  v_cmp_lt_u32 vcc, 1007, v2
  v_mov_b32 v5, 3072
  s_nop 0
  v_cndmask_b32 v65, v65, v5, vcc
  v_and_b32 v6, 31, v1
  v_lshrrev_b32 v7, 5, v1
  v_mul_u32_u24 v2, 96, v6
  v_mad_u32_u24 v66, v7, 48, v2
  v_mov_b32 v67, 0
  s_barrier
  v_lshlrev_b32 v2, 4, v59
  s_mov_b32 s14, 22945792
  buffer_store_dwordx4 v[60:63], v2, s[36:39], s14 offen
  s_mov_b32 s14, 22953984
  buffer_store_dwordx4 v[64:67], v2, s[36:39], s14 offen
  s_lshl_b32 s15, s2, 7
  v_mov_b32 v2, 0
  v_mov_b32 v3, 0
  s_add_u32 s16, s15, 22806528
  s_add_u32 s17, s15, 22872064
  s_mov_b64 exec, 1
  buffer_store_dword v2, v3, s[36:39], s16 offen
  buffer_store_dword v2, v3, s[36:39], s17 offen
  s_mov_b64 exec, -1
  s_endpgm
k1_kernel_lnone:
  s_barrier
  s_lshl_b32 s15, s2, 7
  v_mov_b32 v2, 0
  v_mov_b32 v3, 0
  s_add_u32 s16, s15, 22806528
  s_add_u32 s17, s15, 22872064
  s_mov_b64 exec, 1
  buffer_store_dword v2, v3, s[36:39], s16 offen
  buffer_store_dword v2, v3, s[36:39], s17 offen
  s_mov_b64 exec, -1
  s_endpgm
k1_kernel_lphi:
  s_mov_b32 s60, s2
  s_mov_b32 s61, 153600
  s_load_dwordx2 s[10:11], s[0:1], 40
  s_waitcnt lgkmcnt(0)
  s_mov_b32 s32, s10
  s_mov_b32 s33, s11
  s_mov_b32 s34, 0x6400
  s_mov_b32 s35, 0x00020000
  s_mul_i32 s14, s60, 800
  v_lshlrev_b32 v2, 4, v1
  buffer_load_dwordx4 v[78:81], v2, s[32:35], s14 offen
  s_barrier

  s_barrier
  v_lshlrev_b32 v2, 4, v1
  v_add_u32 v2, s61, v2
  s_waitcnt vmcnt(0)
  ds_write_b128 v2, v[78:81]
  v_and_b32 v3, 31, v1
  v_lshrrev_b32 v4, 3, v3
  v_and_b32 v5, 3, v3
  v_lshl_add_u32 v6, v4, 2, v5
  v_add_u32 v5, 16, v5
  v_lshrrev_b32 v7, 5, v1
  v_mul_u32_u24 v7, 320, v7
  v_lshl_add_u32 v6, v6, 1, v7
  v_lshl_add_u32 v5, v5, 1, v7
  v_add_u32 v6, s61, v6
  v_add_u32 v5, s61, v5
  s_waitcnt lgkmcnt(0)
  ds_read_u16 v78, v6 offset:0
  ds_read_u16 v79, v6 offset:40
  ds_read_u16 v80, v6 offset:80
  ds_read_u16 v81, v6 offset:120
  ds_read_u16 v82, v6 offset:160
  ds_read_u16 v83, v6 offset:200
  ds_read_u16 v84, v6 offset:240
  ds_read_u16 v85, v6 offset:280
  ds_read_u16 v94, v5 offset:0
  ds_read_u16 v95, v5 offset:40
  ds_read_u16 v96, v5 offset:80
  ds_read_u16 v97, v5 offset:120
  ds_read_u16 v98, v5 offset:160
  ds_read_u16 v99, v5 offset:200
  s_barrier
  ds_read_u16 v100, v5 offset:240
  ds_read_u16 v101, v5 offset:280
  v_subrev_u32 v6, v7, v6
  v_subrev_u32 v5, v7, v5
  s_waitcnt lgkmcnt(0)
  ds_read_u16 v86, v6 offset:640
  ds_read_u16 v87, v6 offset:680
  ds_read_u16 v88, v6 offset:720
  ds_read_u16 v89, v6 offset:760
  ds_read_u16 v102, v5 offset:640
  ds_read_u16 v103, v5 offset:680
  ds_read_u16 v104, v5 offset:720
  ds_read_u16 v105, v5 offset:760
  s_waitcnt lgkmcnt(0)
  v_lshl_or_b32 v60, v79, 16, v78
  v_lshl_or_b32 v61, v81, 16, v80
  v_lshl_or_b32 v62, v83, 16, v82
  v_lshl_or_b32 v63, v85, 16, v84
  v_lshl_or_b32 v68, v87, 16, v86
  v_lshl_or_b32 v69, v89, 16, v88
  v_lshl_or_b32 v64, v95, 16, v94
  v_lshl_or_b32 v65, v97, 16, v96
  v_lshl_or_b32 v66, v99, 16, v98
  v_lshl_or_b32 v67, v101, 16, v100
  v_lshl_or_b32 v70, v103, 16, v102
  v_lshl_or_b32 v71, v105, 16, v104
  v_bfe_u32 v2, v3, 2, 1
  v_mov_b32 v7, 0x80008000
  v_mul_lo_u32 v2, v2, v7
  v_xor_b32 v60, v60, v2
  s_barrier
  v_xor_b32 v61, v61, v2
  v_xor_b32 v62, v62, v2
  v_xor_b32 v63, v63, v2
  v_xor_b32 v64, v64, v2
  v_xor_b32 v65, v65, v2
  v_xor_b32 v66, v66, v2
  v_xor_b32 v67, v67, v2
  v_xor_b32 v68, v68, v2
  v_xor_b32 v69, v69, v2
  v_xor_b32 v70, v70, v2
  v_xor_b32 v71, v71, v2
  v_cmp_eq_u32 vcc, 0, v4
  s_nop 1
  v_cndmask_b32 v64, 0, v64, vcc
  s_nop 0
  v_cndmask_b32 v65, 0, v65, vcc
  v_cndmask_b32 v66, 0, v66, vcc
  v_cndmask_b32 v67, 0, v67, vcc
  v_cndmask_b32 v70, 0, v70, vcc
  v_cndmask_b32 v71, 0, v71, vcc
  v_cmp_gt_u32 vcc, 32, v1
  s_nop 1
  v_cndmask_b32 v68, 0, v68, vcc
  s_nop 0
  v_cndmask_b32 v69, 0, v69, vcc
  v_cndmask_b32 v70, 0, v70, vcc
  v_cndmask_b32 v71, 0, v71, vcc
  s_barrier
  s_mul_i32 s14, s2, 3072
  s_add_u32 s14, s14, 22544384
  v_lshlrev_b32 v2, 4, v1
  buffer_store_dwordx4 v[60:63], v2, s[36:39], s14 offen offset:0
  buffer_store_dwordx4 v[64:67], v2, s[36:39], s14 offen offset:1024
  buffer_store_dwordx4 v[68:71], v2, s[36:39], s14 offen offset:2048
  s_lshl_b32 s15, s2, 7
  v_mov_b32 v2, 0
  v_mov_b32 v3, 0
  s_add_u32 s16, s15, 22806528
  s_add_u32 s17, s15, 22872064
  s_mov_b64 exec, 1
  buffer_store_dword v2, v3, s[36:39], s16 offen
  buffer_store_dword v2, v3, s[36:39], s17 offen
  s_mov_b64 exec, -1
  s_endpgm
k1_kernel_end:
  s_endpgm
.globl k2_kernel
.p2align 8
.type k2_kernel,@function
k2_kernel:
  s_cmp_ge_u32 s2, 256
  s_cbranch_scc1 k2_kernel_end
  s_load_dwordx4 s[8:11], s[0:1], 64
  s_load_dwordx2 s[4:5], s[0:1], 16
  s_load_dwordx2 s[6:7], s[0:1], 48
  s_load_dwordx2 s[12:13], s[0:1], 56
  v_and_b32 v1, 63, v0
  v_lshrrev_b32 v2, 6, v0
  s_and_b32 s14, s2, 7
  s_lshl_b32 s14, s14, 2
  v_readfirstlane_b32 s20, v2
  s_bfe_u32 s15, s2, 0x20003
  s_add_u32 s21, s14, s15
  s_lshr_b32 s22, s2, 5
  s_lshr_b32 s23, s20, 2
  s_and_b32 s24, s20, 3
  s_mul_i32 s25, s21, 163840
  s_add_u32 s25, s25, 2621440
  s_add_u32 s47, s25, 8388608
  s_mul_i32 s45, s21, 81920
  s_add_u32 s45, s45, 0
  s_add_u32 s48, s45, 8388608
  s_lshl_b32 s46, s22, 8
  s_lshl_b32 s14, s20, 5
  s_add_u32 s49, s46, s14
  s_lshl_b32 s14, s24, 6
  s_add_u32 s46, s46, s14
  v_lshlrev_b32 v199, 4, v1
  v_and_b32 v6, 31, v1
  v_lshrrev_b32 v7, 5, v1
  v_lshlrev_b32 v2, 15, v7
  v_lshl_add_u32 v2, v6, 4, v2
  v_lshlrev_b32 v3, 3, v6
  v_mul_u32_u24 v4, 320, v7
  v_lshl_add_u32 v4, v6, 4, v4
  s_lshl_b32 s14, s23, 14
  s_lshl_b32 s15, s24, 10
  s_add_u32 s50, s14, s15
  s_mul_i32 s14, s23, 40960
  s_lshl_b32 s16, s24, 11
  s_add_u32 s51, s14, s16
  s_add_u32 s51, s51, 81920
  s_add_u32 s14, s14, s15
  s_add_u32 s14, s14, 88064
  s_lshl_b32 s16, s23, 13
  s_add_u32 s16, s16, s15
  s_add_u32 s16, s16, 65536
  s_cmp_lt_u32 s24, 2
  s_cselect_b32 s52, s16, s14
  s_mov_b32 s15, 10240
  s_cselect_b32 s53, 2048, s15
  s_waitcnt lgkmcnt(0)
  s_mov_b32 s28, s10
  s_mov_b32 s29, s11
  s_mov_b32 s30, 0x10000000
  s_mov_b32 s31, 0x00020000
  v_mov_b32 v242, 0
  v_mov_b32 v243, 0
  s_mov_b32 s34, 0
  s_mov_b32 s35, 0
  v_lshlrev_b32 v2, 15, v7
  v_lshl_add_u32 v2, v6, 4, v2
  v_lshlrev_b32 v3, 3, v6
  s_lshl_b32 s14, s49, 4
  s_add_u32 s14, s14, s47
  buffer_load_dwordx4 v[24:27], v2, s[28:31], s14 offen
  s_lshl_b32 s14, s49, 3
  s_add_u32 s14, s14, s47
  s_add_u32 s14, s14, 65536
  buffer_load_dwordx2 v[28:29], v3, s[28:31], s14 offen
  s_lshr_b32 s14, s49, 5
  s_mul_i32 s14, s14, 1280
  s_add_u32 s14, s14, s47
  s_add_u32 s14, s14, 81920
  buffer_load_dwordx4 v[182:185], v4, s[28:31], s14 offen
  buffer_load_dwordx4 v[186:189], v4, s[28:31], s14 offen offset:640
  s_mul_i32 s14, s21, 3072
  s_add_u32 s14, s14, 22544384
  buffer_load_dwordx4 v[8:11], v199, s[28:31], s14 offen offset:0
  buffer_load_dwordx4 v[12:15], v199, s[28:31], s14 offen offset:1024
  buffer_load_dwordx4 v[16:19], v199, s[28:31], s14 offen offset:2048
  s_mov_b32 s14, 22942720
  buffer_load_dwordx4 v[190:193], v199, s[28:31], s14 offen
  v_lshlrev_b32 v5, 4, v0
  s_mov_b32 s14, 22945792
  buffer_load_dwordx4 v[194:197], v5, s[28:31], s14 offen
  s_mov_b32 s14, 22953984
  buffer_load_dwordx4 v[236:239], v5, s[28:31], s14 offen
  s_lshl_b32 s14, s49, 4
  s_add_u32 s14, s14, s48
  buffer_load_dwordx4 v[30:33], v2, s[28:31], s14 offen
  s_lshl_b32 s14, s49, 3
  s_add_u32 s14, s14, s48
  s_add_u32 s14, s14, 65536
  buffer_load_dwordx2 v[34:35], v3, s[28:31], s14 offen
  s_bfe_u32 s14, s2, 0x10002
  s_cmp_eq_u32 s14, 0
  s_cselect_b32 s4, s4, s6
  s_cselect_b32 s5, s5, s7
  s_mov_b32 s36, s4
  s_mov_b32 s37, s5
  s_mov_b32 s38, 0xc8000
  s_mov_b32 s39, 0x00020000
  v_lshlrev_b32 v149, 15, v7
  v_lshl_add_u32 v149, v6, 4, v149
  s_lshl_b32 s14, s23, 14
  v_add_u32 v149, s14, v149
  s_lshl_b32 s14, s23, 13
  s_add_u32 s14, s14, 65536
  v_lshl_add_u32 v150, v1, 3, s14
  s_mul_i32 s14, s23, 40960
  s_add_u32 s14, s14, 81920
  v_add_u32 v151, s14, v4
  s_mov_b32 s40, 0x000fffff
  s_mov_b32 s41, 0x000fffff
  v_mov_b32 v148, 0xdddd
  v_mov_b32 v152, 0
  v_mov_b32 v153, 0
  s_mov_b32 s54, 0
  s_lshr_b32 s14, s20, 1
  s_lshl_b32 s14, s14, 14
  s_and_b32 s15, s20, 1
  s_mul_i32 s15, s15, 2688
  s_add_u32 s55, s14, s15
  s_add_u32 s55, s55, 8192
  s_mul_i32 s14, s24, 3840
  s_mul_i32 s15, s23, 40960
  s_add_u32 s56, s14, s15
  s_add_u32 s56, s56, 102400
  v_cmp_eq_u32 vcc, 20, v6
  v_mov_b32 v5, 0x3f803f80
  s_nop 0
  v_cndmask_b32 v5, 0, v5, vcc
  v_mov_b32 v132, v5
  v_mov_b32 v133, v5
  v_pk_mov_b32 v[134:135], v[132:133], v[132:133] op_sel:[0,1]
  v_pk_mov_b32 v[136:137], v[132:133], v[132:133] op_sel:[0,1]
  v_pk_mov_b32 v[138:139], v[132:133], v[132:133] op_sel:[0,1]
  v_pk_mov_b32 v[140:141], v[132:133], v[132:133] op_sel:[0,1]
  v_pk_mov_b32 v[142:143], v[132:133], v[132:133] op_sel:[0,1]
  v_pk_mov_b32 v[144:145], v[132:133], v[132:133] op_sel:[0,1]
  v_pk_mov_b32 v[146:147], v[132:133], v[132:133] op_sel:[0,1]
  v_pk_mov_b32 v[72:73], 0, 0
  v_pk_mov_b32 v[74:75], 0, 0
  v_pk_mov_b32 v[76:77], 0, 0
  v_pk_mov_b32 v[78:79], 0, 0
  v_pk_mov_b32 v[80:81], 0, 0
  v_pk_mov_b32 v[82:83], 0, 0
  v_pk_mov_b32 v[84:85], 0, 0
  v_pk_mov_b32 v[86:87], 0, 0
  v_pk_mov_b32 v[88:89], 0, 0
  v_pk_mov_b32 v[90:91], 0, 0
  v_pk_mov_b32 v[92:93], 0, 0
  v_pk_mov_b32 v[94:95], 0, 0
  v_pk_mov_b32 v[96:97], 0, 0
  v_pk_mov_b32 v[98:99], 0, 0
  v_pk_mov_b32 v[100:101], 0, 0
  v_pk_mov_b32 v[102:103], 0, 0
  s_waitcnt vmcnt(2)
  v_lshlrev_b32 v2, 15, v7
  v_lshl_add_u32 v2, v6, 4, v2
  v_lshlrev_b32 v3, 3, v6
  s_lshl_b32 s14, s46, 4
  s_add_u32 s14, s14, s45
  buffer_load_dwordx4 v[104:107], v2, s[28:31], s14 offen
  buffer_load_dwordx4 v[108:111], v2, s[28:31], s14 offen offset:512
  s_lshl_b32 s14, s46, 3
  s_add_u32 s14, s14, s45
  s_add_u32 s14, s14, 65536
  buffer_load_dwordx2 v[112:113], v3, s[28:31], s14 offen
  buffer_load_dwordx2 v[114:115], v3, s[28:31], s14 offen offset:256
  v_add_u32 v190, s55, v190
  v_add_u32 v191, s55, v191
  v_add_u32 v192, s56, v192
  v_add_u32 v193, s56, v193
  v_mov_b32 v240, v196
  v_mov_b32 v241, v197
  v_cmp_eq_u32 vcc, 20, v6
  v_mov_b32 v5, 0x3f803f80
  s_nop 0
  v_cndmask_b32 v182, v182, v5, vcc
  v_cndmask_b32 v183, v183, v5, vcc
  v_cndmask_b32 v184, v184, v5, vcc
  v_cndmask_b32 v185, v185, v5, vcc
  v_cndmask_b32 v186, v186, v5, vcc
  v_cndmask_b32 v187, v187, v5, vcc
  v_cndmask_b32 v188, v188, v5, vcc
  v_cndmask_b32 v189, v189, v5, vcc
  v_mfma_f32_32x32x16_bf16 v[40:55], v[8:11], v[24:27], 0
  v_mfma_f32_32x32x16_bf16 v[56:71], v[12:15], v[24:27], 0
  v_mfma_f32_32x32x8bf16_1k v[40:55], v[16:17], v[28:29], v[40:55]
  v_mfma_f32_32x32x8bf16_1k v[56:71], v[18:19], v[28:29], v[56:71]
  s_nop 7
  s_nop 3
  v_max3_f32 v36, v40, v41, v42
  v_max3_f32 v36, v43, v44, v36
  v_max3_f32 v36, v45, v46, v36
  v_max3_f32 v36, v47, v48, v36
  v_max3_f32 v36, v49, v50, v36
  v_max3_f32 v36, v51, v52, v36
  v_max3_f32 v36, v53, v54, v36
  v_max3_f32 v36, v55, v56, v36
  v_max3_f32 v36, v57, v58, v36
  v_max_f32 v36, v59, v36
  v_mul_f32 v36, 0xbfb8aa3b, v36
  s_mov_b32 s14, 0x3fb8aa3b
  s_mov_b32 s15, 0x3fb8aa3b
  v_mov_b32 v37, v36
  v_pk_fma_f32 v[40:41], v[40:41], s[14:15], v[36:37]
  v_pk_fma_f32 v[42:43], v[42:43], s[14:15], v[36:37]
  v_pk_fma_f32 v[44:45], v[44:45], s[14:15], v[36:37]
  v_pk_fma_f32 v[46:47], v[46:47], s[14:15], v[36:37]
  v_pk_fma_f32 v[48:49], v[48:49], s[14:15], v[36:37]
  v_pk_fma_f32 v[50:51], v[50:51], s[14:15], v[36:37]
  v_pk_fma_f32 v[52:53], v[52:53], s[14:15], v[36:37]
  v_pk_fma_f32 v[54:55], v[54:55], s[14:15], v[36:37]
  v_pk_fma_f32 v[56:57], v[56:57], s[14:15], v[36:37]
  v_pk_fma_f32 v[58:59], v[58:59], s[14:15], v[36:37]
  v_exp_f32 v40, v40
  v_exp_f32 v41, v41
  v_exp_f32 v42, v42
  v_exp_f32 v43, v43
  v_exp_f32 v44, v44
  v_exp_f32 v45, v45
  v_exp_f32 v46, v46
  v_exp_f32 v47, v47
  v_exp_f32 v48, v48
  v_exp_f32 v49, v49
  v_exp_f32 v50, v50
  v_exp_f32 v51, v51
  v_exp_f32 v52, v52
  v_exp_f32 v53, v53
  v_exp_f32 v54, v54
  v_exp_f32 v55, v55
  v_exp_f32 v56, v56
  v_exp_f32 v57, v57
  v_exp_f32 v58, v58
  v_exp_f32 v59, v59
  s_nop 0
  v_pk_add_f32 v[38:39], v[40:41], v[42:43]
  v_pk_add_f32 v[38:39], v[38:39], v[44:45]
  v_pk_add_f32 v[38:39], v[38:39], v[46:47]
  v_pk_add_f32 v[38:39], v[38:39], v[48:49]
  v_pk_add_f32 v[38:39], v[38:39], v[50:51]
  v_pk_add_f32 v[38:39], v[38:39], v[52:53]
  v_pk_add_f32 v[38:39], v[38:39], v[54:55]
  v_pk_add_f32 v[38:39], v[38:39], v[56:57]
  v_pk_add_f32 v[38:39], v[38:39], v[58:59]
  v_add_f32 v38, v38, v39
  v_rcp_f32 v38, v38
  s_nop 0
  v_mov_b32 v39, v38
  v_pk_mul_f32 v[40:41], v[40:41], v[38:39]
  v_pk_mul_f32 v[42:43], v[42:43], v[38:39]
  v_pk_mul_f32 v[44:45], v[44:45], v[38:39]
  v_pk_mul_f32 v[46:47], v[46:47], v[38:39]
  v_pk_mul_f32 v[48:49], v[48:49], v[38:39]
  v_pk_mul_f32 v[50:51], v[50:51], v[38:39]
  v_pk_mul_f32 v[52:53], v[52:53], v[38:39]
  v_pk_mul_f32 v[54:55], v[54:55], v[38:39]
  v_pk_mul_f32 v[56:57], v[56:57], v[38:39]
  v_pk_mul_f32 v[58:59], v[58:59], v[38:39]
  v_cvt_pk_bf16_f32 v120, v40, v41
  v_cvt_pk_bf16_f32 v121, v42, v43
  v_cvt_pk_bf16_f32 v122, v44, v45
  v_cvt_pk_bf16_f32 v123, v46, v47
  v_cvt_pk_bf16_f32 v124, v48, v49
  v_cvt_pk_bf16_f32 v125, v50, v51
  v_cvt_pk_bf16_f32 v126, v52, v53
  v_cvt_pk_bf16_f32 v127, v54, v55
  v_cvt_pk_bf16_f32 v128, v56, v57
  v_cvt_pk_bf16_f32 v129, v58, v59
  v_mov_b32 v130, 0
  v_mov_b32 v131, 0
  ds_write_b64 v190, v[120:121] offset:0
  ds_write_b64 v190, v[122:123] offset:8
  ds_write_b64 v190, v[124:125] offset:16
  ds_write_b64 v190, v[126:127] offset:24
  ds_write_b64 v190, v[128:129] offset:32
  s_waitcnt lgkmcnt(0)
  ds_read_b64_tr_b16 v[154:155], v191 offset:0
  ds_read_b64_tr_b16 v[156:157], v191 offset:320
  ds_read_b64_tr_b16 v[158:159], v191 offset:64
  ds_read_b64_tr_b16 v[160:161], v191 offset:384
  ds_read_b64_tr_b16 v[162:163], v191 offset:1280
  ds_read_b64_tr_b16 v[164:165], v191 offset:1600
  ds_read_b64_tr_b16 v[166:167], v191 offset:1344
  ds_read_b64_tr_b16 v[168:169], v191 offset:1664
  s_waitcnt lgkmcnt(6)
  v_mfma_f32_32x32x16_bf16 v[204:219], v[182:185], v[154:157], 0
  s_waitcnt lgkmcnt(4)
  v_mfma_f32_32x32x16_bf16 v[220:235], v[182:185], v[158:161], 0
  s_waitcnt lgkmcnt(2)
  v_mfma_f32_32x32x16_bf16 v[204:219], v[186:189], v[162:165], v[204:219]
  s_waitcnt lgkmcnt(0)
  v_mfma_f32_32x32x16_bf16 v[220:235], v[186:189], v[166:169], v[220:235]
  s_mov_b32 m0, s50
  s_add_u32 s14, s50, s25
  buffer_load_dwordx4 v199, s[28:31], s14 offen  lds
  s_add_u32 m0, s50, 32768
  s_add_u32 s14, s14, 32768
  buffer_load_dwordx4 v199, s[28:31], s14 offen  lds
  s_mov_b32 m0, s51
  s_add_u32 s14, s51, s25
  buffer_load_dwordx4 v199, s[28:31], s14 offen  lds
  buffer_load_dwordx4 v199, s[28:31], s14 offen offset:1024  lds
  s_mov_b32 m0, s52
  s_add_u32 s14, s52, s25
  buffer_load_dwordx4 v199, s[28:31], s14 offen  lds
  s_add_u32 s50, s50, 4096
  s_add_u32 s51, s51, 10240
  s_add_u32 s52, s52, s53
  s_waitcnt vmcnt(9)
  v_mfma_f32_32x32x16_bf16 v[40:55], v[8:11], v[30:33], 0
  v_mfma_f32_32x32x16_bf16 v[56:71], v[12:15], v[30:33], 0
  v_mfma_f32_32x32x8bf16_1k v[40:55], v[16:17], v[34:35], v[40:55]
  v_mfma_f32_32x32x8bf16_1k v[56:71], v[18:19], v[34:35], v[56:71]
  s_nop 7
  s_nop 3
  v_max3_f32 v36, v40, v41, v42
  v_max3_f32 v36, v43, v44, v36
  v_max3_f32 v36, v45, v46, v36
  v_max3_f32 v36, v47, v48, v36
  v_max3_f32 v36, v49, v50, v36
  v_max3_f32 v36, v51, v52, v36
  v_max3_f32 v36, v53, v54, v36
  v_max3_f32 v36, v55, v56, v36
  v_max3_f32 v36, v57, v58, v36
  v_max_f32 v36, v59, v36
  v_mul_f32 v36, 0xbfb8aa3b, v36
  s_mov_b32 s14, 0x3fb8aa3b
  s_mov_b32 s15, 0x3fb8aa3b
  v_mov_b32 v37, v36
  v_pk_fma_f32 v[40:41], v[40:41], s[14:15], v[36:37]
  v_pk_fma_f32 v[42:43], v[42:43], s[14:15], v[36:37]
  v_pk_fma_f32 v[44:45], v[44:45], s[14:15], v[36:37]
  v_pk_fma_f32 v[46:47], v[46:47], s[14:15], v[36:37]
  v_pk_fma_f32 v[48:49], v[48:49], s[14:15], v[36:37]
  v_pk_fma_f32 v[50:51], v[50:51], s[14:15], v[36:37]
  v_pk_fma_f32 v[52:53], v[52:53], s[14:15], v[36:37]
  v_pk_fma_f32 v[54:55], v[54:55], s[14:15], v[36:37]
  v_pk_fma_f32 v[56:57], v[56:57], s[14:15], v[36:37]
  v_pk_fma_f32 v[58:59], v[58:59], s[14:15], v[36:37]
  v_exp_f32 v40, v40
  v_exp_f32 v41, v41
  v_exp_f32 v42, v42
  v_exp_f32 v43, v43
  v_exp_f32 v44, v44
  v_exp_f32 v45, v45
  v_exp_f32 v46, v46
  v_exp_f32 v47, v47
  v_exp_f32 v48, v48
  v_exp_f32 v49, v49
  v_exp_f32 v50, v50
  v_exp_f32 v51, v51
  v_exp_f32 v52, v52
  v_exp_f32 v53, v53
  v_exp_f32 v54, v54
  v_exp_f32 v55, v55
  v_exp_f32 v56, v56
  v_exp_f32 v57, v57
  v_exp_f32 v58, v58
  v_exp_f32 v59, v59
  s_nop 0
  v_pk_add_f32 v[38:39], v[40:41], v[42:43]
  v_pk_add_f32 v[38:39], v[38:39], v[44:45]
  v_pk_add_f32 v[38:39], v[38:39], v[46:47]
  v_pk_add_f32 v[38:39], v[38:39], v[48:49]
  v_pk_add_f32 v[38:39], v[38:39], v[50:51]
  v_pk_add_f32 v[38:39], v[38:39], v[52:53]
  v_pk_add_f32 v[38:39], v[38:39], v[54:55]
  v_pk_add_f32 v[38:39], v[38:39], v[56:57]
  v_pk_add_f32 v[38:39], v[38:39], v[58:59]
  v_add_f32 v38, v38, v39
  v_rcp_f32 v38, v38
  s_nop 0
  v_mov_b32 v39, v38
  v_pk_mul_f32 v[40:41], v[40:41], v[38:39]
  v_pk_mul_f32 v[42:43], v[42:43], v[38:39]
  v_pk_mul_f32 v[44:45], v[44:45], v[38:39]
  v_pk_mul_f32 v[46:47], v[46:47], v[38:39]
  v_pk_mul_f32 v[48:49], v[48:49], v[38:39]
  v_pk_mul_f32 v[50:51], v[50:51], v[38:39]
  v_pk_mul_f32 v[52:53], v[52:53], v[38:39]
  v_pk_mul_f32 v[54:55], v[54:55], v[38:39]
  v_pk_mul_f32 v[56:57], v[56:57], v[38:39]
  v_pk_mul_f32 v[58:59], v[58:59], v[38:39]
  v_cvt_pk_bf16_f32 v170, v40, v41
  v_cvt_pk_bf16_f32 v171, v42, v43
  v_cvt_pk_bf16_f32 v172, v44, v45
  v_cvt_pk_bf16_f32 v173, v46, v47
  v_cvt_pk_bf16_f32 v174, v48, v49
  v_cvt_pk_bf16_f32 v175, v50, v51
  v_cvt_pk_bf16_f32 v176, v52, v53
  v_cvt_pk_bf16_f32 v177, v54, v55
  v_cvt_pk_bf16_f32 v178, v56, v57
  v_cvt_pk_bf16_f32 v179, v58, v59
  v_mov_b32 v180, 0
  v_mov_b32 v181, 0
  ds_write_b32 v192, v204 offset:0
  ds_write_b32 v192, v205 offset:128
  ds_write_b32 v192, v206 offset:256
  ds_write_b32 v192, v207 offset:384
  ds_write_b32 v192, v208 offset:1024
  ds_write_b32 v192, v209 offset:1152
  ds_write_b32 v192, v210 offset:1280
  ds_write_b32 v192, v211 offset:1408
  ds_write_b32 v192, v212 offset:2048
  ds_write_b32 v192, v213 offset:2176
  ds_write_b32 v192, v214 offset:2304
  ds_write_b32 v192, v215 offset:2432
  s_mov_b32 exec_lo, 0xff
  s_mov_b32 exec_hi, 0xff
  ds_write_b32 v193, v220 offset:3072
  ds_write_b32 v193, v221 offset:3104
  ds_write_b32 v193, v222 offset:3136
  ds_write_b32 v193, v223 offset:3168
  ds_write_b32 v193, v224 offset:3328
  ds_write_b32 v193, v225 offset:3360
  ds_write_b32 v193, v226 offset:3392
  ds_write_b32 v193, v227 offset:3424
  ds_write_b32 v193, v228 offset:3584
  ds_write_b32 v193, v229 offset:3616
  ds_write_b32 v193, v230 offset:3648
  ds_write_b32 v193, v231 offset:3680
  s_mov_b64 exec, -1
  v_mov_b32 v64, 0
  v_mov_b32 v65, 0
  v_mov_b32 v66, 0
  v_mov_b32 v67, 0
  v_mov_b32 v68, 0
  v_mov_b32 v69, 0
  v_mov_b32 v70, 0
  v_mov_b32 v71, 0
  s_waitcnt vmcnt(0)
  v_cmp_gt_u32 vcc, 32, v1
  s_nop 1
  v_cndmask_b32 v116, v112, 0, vcc
  v_cndmask_b32 v112, 0, v112, vcc
  v_cndmask_b32 v117, v113, 0, vcc
  v_cndmask_b32 v113, 0, v113, vcc
  v_cndmask_b32 v118, v114, 0, vcc
  v_cndmask_b32 v114, 0, v114, vcc
  v_cndmask_b32 v119, v115, 0, vcc
  v_cndmask_b32 v115, 0, v115, vcc
  s_waitcnt lgkmcnt(0)
  s_barrier
  ds_read_b128 v[120:123], v149 offset:0
  ds_read_b64 v[128:129], v150 offset:0
  ds_read_b128 v[124:127], v149 offset:512
  s_mov_b64 exec, s[40:41]
  ds_read_b128 v[132:135], v151 offset:0
  ds_read_b128 v[140:143], v151 offset:640
  s_mov_b64 exec, -1
  s_mov_b32 m0, s50
  s_add_u32 s14, s50, s25
  buffer_load_dwordx4 v199, s[28:31], s14 offen  lds
  s_add_u32 m0, s50, 32768
  s_add_u32 s14, s14, 32768
  buffer_load_dwordx4 v199, s[28:31], s14 offen  lds
  s_mov_b32 m0, s51
  s_add_u32 s14, s51, s25
  buffer_load_dwordx4 v199, s[28:31], s14 offen  lds
  buffer_load_dwordx4 v199, s[28:31], s14 offen offset:1024  lds
  s_mov_b32 m0, s52
  s_add_u32 s14, s52, s25
  buffer_load_dwordx4 v199, s[28:31], s14 offen  lds
  s_add_u32 s50, s50, 4096
  s_add_u32 s51, s51, 10240
  s_add_u32 s52, s52, s53
  s_waitcnt lgkmcnt(3)
  v_mfma_f32_32x32x16_bf16 v[8:23], v[120:123], v[104:107], 0
  v_mfma_f32_32x32x8bf16_1k v[8:23], v[128:129], v[112:113], v[8:23]
  s_waitcnt lgkmcnt(0)
  ds_read_b32 v154, v194 offset:0
  ds_read_b32 v155, v194 offset:3840
  ds_read_b32 v156, v194 offset:7680
  ds_read_b32 v157, v194 offset:11520
  ds_read_b32 v158, v194 offset:40960
  ds_read_b32 v159, v194 offset:44800
  ds_read_b32 v160, v194 offset:48640
  ds_read_b32 v161, v194 offset:52480
  ds_read_b32 v162, v195 offset:0
  ds_read_b32 v163, v195 offset:3840
  ds_read_b32 v164, v195 offset:7680
  ds_read_b32 v165, v195 offset:11520
  ds_read_b32 v166, v195 offset:40960
  ds_read_b32 v167, v195 offset:44800
  ds_read_b32 v168, v195 offset:48640
  ds_read_b32 v169, v195 offset:52480
  s_lshl_b32 s14, s21, 3
  s_add_u32 s14, s14, s22
  s_mul_i32 s14, s14, 3360
  s_add_u32 s14, s14, 23068672
  s_waitcnt lgkmcnt(0)
  v_add_f32 v154, v154, v155
  v_add_f32 v162, v162, v163
  v_add_f32 v154, v154, v156
  v_add_f32 v162, v162, v164
  v_add_f32 v154, v154, v157
  v_add_f32 v162, v162, v165
  v_add_f32 v154, v154, v158
  v_add_f32 v162, v162, v166
  v_add_f32 v154, v154, v159
  v_add_f32 v162, v162, v167
  v_add_f32 v154, v154, v160
  v_add_f32 v162, v162, v168
  v_add_f32 v154, v154, v161
  v_add_f32 v162, v162, v169
  buffer_store_dword v154, v196, s[28:31], s14 offen sc1
  buffer_store_dword v162, v197, s[28:31], s14 offen sc1
  s_cmp_eq_u32 s23, 0
  s_cselect_b32 s27, 1, 0
  s_cselect_b32 s58, 2, 0
  s_mov_b32 s14, 99
  s_cselect_b32 s59, 3, s14
  s_cmp_eq_u32 s27, 0
  s_cbranch_scc1 k2_kernel_pB
  s_setprio 2
  s_branch k2_kernel_pC
k2_kernel_pB:
  s_setprio 1
k2_kernel_pC:
  s_mov_b32 s26, 0
  s_mov_b32 s60, 4
.p2align 6
k2_kernel_loop:
  s_cmp_eq_u32 s26, 1
  s_cbranch_scc1 k2_kernel_dma7
k2_kernel_dma7r:
  v_mfma_f32_32x32x16_bf16 v[24:39], v[120:123], v[108:111], 0
  v_exp_f32 v8, v8
  v_exp_f32 v9, v9
  v_exp_f32 v10, v10
  v_exp_f32 v11, v11
  v_mfma_f32_32x32x8bf16_1k v[24:39], v[128:129], v[114:115], v[24:39]
  v_exp_f32 v12, v12
  v_exp_f32 v13, v13
  v_exp_f32 v14, v14
  v_exp_f32 v15, v15
  v_smfmac_f32_32x32x32_bf16 v[88:103], v[144:147], v[64:71], v148
  s_mov_b64 exec, s[40:41]
  ds_read_b128 v[136:139], v151 offset:1280
  ds_read_b128 v[144:147], v151 offset:1920
  s_mov_b64 exec, -1
  v_exp_f32 v16, v16
  v_exp_f32 v17, v17
  v_exp_f32 v18, v18
  v_exp_f32 v19, v19
  s_waitcnt lgkmcnt(4)
  v_smfmac_f32_32x32x32_bf16 v[72:87], v[132:135], v[8:15], v148
  v_exp_f32 v20, v20
  v_exp_f32 v21, v21
  v_exp_f32 v22, v22
  v_exp_f32 v23, v23
  s_cbranch_scc1 k2_kernel_dma8
k2_kernel_dma8r:
  ds_read_b128 v[120:123], v149 offset:1024
  ds_read_b64 v[130:131], v150 offset:512
  s_waitcnt lgkmcnt(4)
  v_mfma_f32_32x32x16_bf16 v[40:55], v[124:127], v[104:107], 0
  v_exp_f32 v24, v24
  v_exp_f32 v25, v25
  v_exp_f32 v26, v26
  v_exp_f32 v27, v27
  v_mfma_f32_32x32x8bf16_1k v[40:55], v[128:129], v[116:117], v[40:55]
  v_exp_f32 v28, v28
  v_exp_f32 v29, v29
  v_exp_f32 v30, v30
  v_exp_f32 v31, v31
  v_smfmac_f32_32x32x32_bf16 v[72:87], v[140:143], v[16:23], v148
  v_exp_f32 v32, v32
  v_exp_f32 v33, v33
  v_exp_f32 v34, v34
  v_exp_f32 v35, v35
  v_smfmac_f32_32x32x32_bf16 v[88:103], v[132:135], v[24:31], v148
  v_exp_f32 v36, v36
  v_exp_f32 v37, v37
  v_exp_f32 v38, v38
  v_exp_f32 v39, v39
  s_cbranch_scc1 k2_kernel_dma9
k2_kernel_dma9r:
  v_mfma_f32_32x32x16_bf16 v[56:71], v[124:127], v[108:111], 0
  v_exp_f32 v40, v40
  v_exp_f32 v41, v41
  v_exp_f32 v42, v42
  v_exp_f32 v43, v43
  v_mfma_f32_32x32x8bf16_1k v[56:71], v[128:129], v[118:119], v[56:71]
  v_exp_f32 v44, v44
  v_exp_f32 v45, v45
  v_exp_f32 v46, v46
  v_exp_f32 v47, v47
  v_smfmac_f32_32x32x32_bf16 v[88:103], v[140:143], v[32:39], v148
  s_mov_b64 exec, s[40:41]
  ds_read_b128 v[132:135], v151 offset:2560
  ds_read_b128 v[140:143], v151 offset:3200
  s_mov_b64 exec, -1
  v_exp_f32 v48, v48
  v_exp_f32 v49, v49
  v_exp_f32 v50, v50
  v_exp_f32 v51, v51
  s_waitcnt lgkmcnt(5)
  v_smfmac_f32_32x32x32_bf16 v[72:87], v[136:139], v[40:47], v148
  v_exp_f32 v52, v52
  v_exp_f32 v53, v53
  v_exp_f32 v54, v54
  v_exp_f32 v55, v55
  ds_read_b128 v[124:127], v149 offset:1536
  s_waitcnt lgkmcnt(4)
  v_mfma_f32_32x32x16_bf16 v[8:23], v[120:123], v[104:107], 0
  v_exp_f32 v56, v56
  v_exp_f32 v57, v57
  v_exp_f32 v58, v58
  v_exp_f32 v59, v59
  s_waitcnt lgkmcnt(3)
  v_mfma_f32_32x32x8bf16_1k v[8:23], v[130:131], v[112:113], v[8:23]
  v_exp_f32 v60, v60
  v_exp_f32 v61, v61
  v_exp_f32 v62, v62
  v_exp_f32 v63, v63
  v_smfmac_f32_32x32x32_bf16 v[72:87], v[144:147], v[48:55], v148
  v_exp_f32 v64, v64
  v_exp_f32 v65, v65
  v_exp_f32 v66, v66
  v_exp_f32 v67, v67
  v_smfmac_f32_32x32x32_bf16 v[88:103], v[136:139], v[56:63], v148
  v_exp_f32 v68, v68
  v_exp_f32 v69, v69
  v_exp_f32 v70, v70
  v_exp_f32 v71, v71
  s_cmp_lt_u32 s26, s58
  s_cbranch_scc1 k2_kernel_prio1
k2_kernel_prio1r:
  v_mfma_f32_32x32x16_bf16 v[24:39], v[120:123], v[108:111], 0
  v_exp_f32 v8, v8
  v_exp_f32 v9, v9
  v_exp_f32 v10, v10
  v_exp_f32 v11, v11
  v_mfma_f32_32x32x8bf16_1k v[24:39], v[130:131], v[114:115], v[24:39]
  v_exp_f32 v12, v12
  v_exp_f32 v13, v13
  v_exp_f32 v14, v14
  v_exp_f32 v15, v15
  v_smfmac_f32_32x32x32_bf16 v[88:103], v[144:147], v[64:71], v148
  s_mov_b64 exec, s[40:41]
  ds_read_b128 v[136:139], v151 offset:3840
  ds_read_b128 v[144:147], v151 offset:4480
  s_mov_b64 exec, -1
  v_exp_f32 v16, v16
  v_exp_f32 v17, v17
  v_exp_f32 v18, v18
  v_exp_f32 v19, v19
  s_waitcnt lgkmcnt(4)
  v_smfmac_f32_32x32x32_bf16 v[72:87], v[132:135], v[8:15], v148
  v_exp_f32 v20, v20
  v_exp_f32 v21, v21
  v_exp_f32 v22, v22
  v_exp_f32 v23, v23
  ds_read_b128 v[120:123], v149 offset:2048
  ds_read_b64 v[128:129], v150 offset:1024
  s_waitcnt lgkmcnt(4)
  v_mfma_f32_32x32x16_bf16 v[40:55], v[124:127], v[104:107], 0
  v_exp_f32 v24, v24
  v_exp_f32 v25, v25
  v_exp_f32 v26, v26
  v_exp_f32 v27, v27
  v_mfma_f32_32x32x8bf16_1k v[40:55], v[130:131], v[116:117], v[40:55]
  v_exp_f32 v28, v28
  v_exp_f32 v29, v29
  v_exp_f32 v30, v30
  v_exp_f32 v31, v31
  v_smfmac_f32_32x32x32_bf16 v[72:87], v[140:143], v[16:23], v148
  v_exp_f32 v32, v32
  v_exp_f32 v33, v33
  v_exp_f32 v34, v34
  v_exp_f32 v35, v35
  v_smfmac_f32_32x32x32_bf16 v[88:103], v[132:135], v[24:31], v148
  v_exp_f32 v36, v36
  v_exp_f32 v37, v37
  v_exp_f32 v38, v38
  v_exp_f32 v39, v39
  s_cmp_eq_u32 s26, s59
  s_cbranch_scc1 k2_kernel_prio2
k2_kernel_prio2r:
  v_mfma_f32_32x32x16_bf16 v[56:71], v[124:127], v[108:111], 0
  v_exp_f32 v40, v40
  v_exp_f32 v41, v41
  v_exp_f32 v42, v42
  v_exp_f32 v43, v43
  v_mfma_f32_32x32x8bf16_1k v[56:71], v[130:131], v[118:119], v[56:71]
  v_exp_f32 v44, v44
  v_exp_f32 v45, v45
  v_exp_f32 v46, v46
  v_exp_f32 v47, v47
  v_smfmac_f32_32x32x32_bf16 v[88:103], v[140:143], v[32:39], v148
  s_mov_b64 exec, s[40:41]
  ds_read_b128 v[132:135], v151 offset:5120
  ds_read_b128 v[140:143], v151 offset:5760
  s_mov_b64 exec, -1
  v_exp_f32 v48, v48
  v_exp_f32 v49, v49
  v_exp_f32 v50, v50
  v_exp_f32 v51, v51
  s_waitcnt lgkmcnt(5)
  v_smfmac_f32_32x32x32_bf16 v[72:87], v[136:139], v[40:47], v148
  v_exp_f32 v52, v52
  v_exp_f32 v53, v53
  v_exp_f32 v54, v54
  v_exp_f32 v55, v55
  ds_read_b128 v[124:127], v149 offset:2560
  s_waitcnt lgkmcnt(4)
  v_mfma_f32_32x32x16_bf16 v[8:23], v[120:123], v[104:107], 0
  v_exp_f32 v56, v56
  v_exp_f32 v57, v57
  v_exp_f32 v58, v58
  v_exp_f32 v59, v59
  s_waitcnt lgkmcnt(3)
  v_mfma_f32_32x32x8bf16_1k v[8:23], v[128:129], v[112:113], v[8:23]
  v_exp_f32 v60, v60
  v_exp_f32 v61, v61
  v_exp_f32 v62, v62
  v_exp_f32 v63, v63
  v_smfmac_f32_32x32x32_bf16 v[72:87], v[144:147], v[48:55], v148
  v_exp_f32 v64, v64
  v_exp_f32 v65, v65
  v_exp_f32 v66, v66
  v_exp_f32 v67, v67
  v_smfmac_f32_32x32x32_bf16 v[88:103], v[136:139], v[56:63], v148
  v_exp_f32 v68, v68
  v_exp_f32 v69, v69
  v_exp_f32 v70, v70
  v_exp_f32 v71, v71
  s_cmp_lt_u32 s26, s60
  s_cbranch_scc1 k2_kernel_hook
k2_kernel_hookret:
  s_cmp_eq_u32 s26, 0
  v_mfma_f32_32x32x16_bf16 v[24:39], v[120:123], v[108:111], 0
  v_exp_f32 v8, v8
  v_exp_f32 v9, v9
  v_exp_f32 v10, v10
  v_exp_f32 v11, v11
  v_mfma_f32_32x32x8bf16_1k v[24:39], v[128:129], v[114:115], v[24:39]
  v_exp_f32 v12, v12
  v_exp_f32 v13, v13
  v_exp_f32 v14, v14
  v_exp_f32 v15, v15
  v_smfmac_f32_32x32x32_bf16 v[88:103], v[144:147], v[64:71], v148
  s_mov_b64 exec, s[40:41]
  ds_read_b128 v[136:139], v151 offset:6400
  ds_read_b128 v[144:147], v151 offset:7040
  s_mov_b64 exec, -1
  v_exp_f32 v16, v16
  v_exp_f32 v17, v17
  v_exp_f32 v18, v18
  v_exp_f32 v19, v19
  s_waitcnt lgkmcnt(4)
  v_smfmac_f32_32x32x32_bf16 v[72:87], v[132:135], v[8:15], v148
  v_exp_f32 v20, v20
  v_exp_f32 v21, v21
  v_exp_f32 v22, v22
  v_exp_f32 v23, v23
  s_cbranch_scc1 k2_kernel_dma0
k2_kernel_dma0r:
  ds_read_b128 v[120:123], v149 offset:3072
  ds_read_b64 v[130:131], v150 offset:1536
  s_waitcnt lgkmcnt(4)
  v_mfma_f32_32x32x16_bf16 v[40:55], v[124:127], v[104:107], 0
  v_exp_f32 v24, v24
  v_exp_f32 v25, v25
  v_exp_f32 v26, v26
  v_exp_f32 v27, v27
  v_mfma_f32_32x32x8bf16_1k v[40:55], v[128:129], v[116:117], v[40:55]
  v_exp_f32 v28, v28
  v_exp_f32 v29, v29
  v_exp_f32 v30, v30
  v_exp_f32 v31, v31
  v_smfmac_f32_32x32x32_bf16 v[72:87], v[140:143], v[16:23], v148
  v_exp_f32 v32, v32
  v_exp_f32 v33, v33
  v_exp_f32 v34, v34
  v_exp_f32 v35, v35
  v_smfmac_f32_32x32x32_bf16 v[88:103], v[132:135], v[24:31], v148
  v_exp_f32 v36, v36
  v_exp_f32 v37, v37
  v_exp_f32 v38, v38
  v_exp_f32 v39, v39
  s_cbranch_scc1 k2_kernel_dma1
k2_kernel_dma1r:
  v_mfma_f32_32x32x16_bf16 v[56:71], v[124:127], v[108:111], 0
  v_exp_f32 v40, v40
  v_exp_f32 v41, v41
  v_exp_f32 v42, v42
  v_exp_f32 v43, v43
  v_mfma_f32_32x32x8bf16_1k v[56:71], v[128:129], v[118:119], v[56:71]
  v_exp_f32 v44, v44
  v_exp_f32 v45, v45
  v_exp_f32 v46, v46
  v_exp_f32 v47, v47
  v_smfmac_f32_32x32x32_bf16 v[88:103], v[140:143], v[32:39], v148
  s_mov_b64 exec, s[40:41]
  ds_read_b128 v[132:135], v151 offset:7680
  ds_read_b128 v[140:143], v151 offset:8320
  s_mov_b64 exec, -1
  v_exp_f32 v48, v48
  v_exp_f32 v49, v49
  v_exp_f32 v50, v50
  v_exp_f32 v51, v51
  s_waitcnt lgkmcnt(5)
  v_smfmac_f32_32x32x32_bf16 v[72:87], v[136:139], v[40:47], v148
  v_exp_f32 v52, v52
  v_exp_f32 v53, v53
  v_exp_f32 v54, v54
  v_exp_f32 v55, v55
  s_cbranch_scc1 k2_kernel_dma2
k2_kernel_dma2r:
  ds_read_b128 v[124:127], v149 offset:3584
  s_waitcnt lgkmcnt(4)
  v_mfma_f32_32x32x16_bf16 v[8:23], v[120:123], v[104:107], 0
  v_exp_f32 v56, v56
  v_exp_f32 v57, v57
  v_exp_f32 v58, v58
  v_exp_f32 v59, v59
  s_waitcnt lgkmcnt(3)
  v_mfma_f32_32x32x8bf16_1k v[8:23], v[130:131], v[112:113], v[8:23]
  v_exp_f32 v60, v60
  v_exp_f32 v61, v61
  v_exp_f32 v62, v62
  v_exp_f32 v63, v63
  v_smfmac_f32_32x32x32_bf16 v[72:87], v[144:147], v[48:55], v148
  v_exp_f32 v64, v64
  v_exp_f32 v65, v65
  v_exp_f32 v66, v66
  v_exp_f32 v67, v67
  v_smfmac_f32_32x32x32_bf16 v[88:103], v[136:139], v[56:63], v148
  v_exp_f32 v68, v68
  v_exp_f32 v69, v69
  v_exp_f32 v70, v70
  v_exp_f32 v71, v71
  s_cbranch_scc1 k2_kernel_dma3
k2_kernel_dma3r:
  v_mfma_f32_32x32x16_bf16 v[24:39], v[120:123], v[108:111], 0
  v_exp_f32 v8, v8
  v_exp_f32 v9, v9
  v_exp_f32 v10, v10
  v_exp_f32 v11, v11
  v_mfma_f32_32x32x8bf16_1k v[24:39], v[130:131], v[114:115], v[24:39]
  v_exp_f32 v12, v12
  v_exp_f32 v13, v13
  v_exp_f32 v14, v14
  v_exp_f32 v15, v15
  v_smfmac_f32_32x32x32_bf16 v[88:103], v[144:147], v[64:71], v148
  s_mov_b64 exec, s[40:41]
  ds_read_b128 v[136:139], v151 offset:8960
  ds_read_b128 v[144:147], v151 offset:9600
  s_mov_b64 exec, -1
  v_exp_f32 v16, v16
  v_exp_f32 v17, v17
  v_exp_f32 v18, v18
  v_exp_f32 v19, v19
  s_waitcnt lgkmcnt(4)
  v_smfmac_f32_32x32x32_bf16 v[72:87], v[132:135], v[8:15], v148
  v_exp_f32 v20, v20
  v_exp_f32 v21, v21
  v_exp_f32 v22, v22
  v_exp_f32 v23, v23
  s_cbranch_scc1 k2_kernel_dma4
k2_kernel_dma4r:
  ds_read_b128 v[120:123], v149 offset:4096
  ds_read_b64 v[128:129], v150 offset:2048
  s_waitcnt lgkmcnt(4)
  v_mfma_f32_32x32x16_bf16 v[40:55], v[124:127], v[104:107], 0
  v_exp_f32 v24, v24
  v_exp_f32 v25, v25
  v_exp_f32 v26, v26
  v_exp_f32 v27, v27
  v_mfma_f32_32x32x8bf16_1k v[40:55], v[130:131], v[116:117], v[40:55]
  v_exp_f32 v28, v28
  v_exp_f32 v29, v29
  v_exp_f32 v30, v30
  v_exp_f32 v31, v31
  v_smfmac_f32_32x32x32_bf16 v[72:87], v[140:143], v[16:23], v148
  v_exp_f32 v32, v32
  v_exp_f32 v33, v33
  v_exp_f32 v34, v34
  v_exp_f32 v35, v35
  v_smfmac_f32_32x32x32_bf16 v[88:103], v[132:135], v[24:31], v148
  v_exp_f32 v36, v36
  v_exp_f32 v37, v37
  v_exp_f32 v38, v38
  v_exp_f32 v39, v39
  s_cbranch_scc1 k2_kernel_dma5
k2_kernel_dma5r:
  v_mfma_f32_32x32x16_bf16 v[56:71], v[124:127], v[108:111], 0
  v_exp_f32 v40, v40
  v_exp_f32 v41, v41
  v_exp_f32 v42, v42
  v_exp_f32 v43, v43
  v_mfma_f32_32x32x8bf16_1k v[56:71], v[130:131], v[118:119], v[56:71]
  v_exp_f32 v44, v44
  v_exp_f32 v45, v45
  v_exp_f32 v46, v46
  v_exp_f32 v47, v47
  v_smfmac_f32_32x32x32_bf16 v[88:103], v[140:143], v[32:39], v148
  s_mov_b64 exec, s[40:41]
  ds_read_b128 v[132:135], v151 offset:10240
  ds_read_b128 v[140:143], v151 offset:10880
  s_mov_b64 exec, -1
  v_exp_f32 v48, v48
  v_exp_f32 v49, v49
  v_exp_f32 v50, v50
  v_exp_f32 v51, v51
  s_waitcnt lgkmcnt(5)
  v_smfmac_f32_32x32x32_bf16 v[72:87], v[136:139], v[40:47], v148
  v_exp_f32 v52, v52
  v_exp_f32 v53, v53
  v_exp_f32 v54, v54
  v_exp_f32 v55, v55
  s_cbranch_scc1 k2_kernel_dma6
k2_kernel_dma6r:
  ds_read_b128 v[124:127], v149 offset:4608
  s_waitcnt lgkmcnt(4)
  v_mfma_f32_32x32x16_bf16 v[8:23], v[120:123], v[104:107], 0
  v_exp_f32 v56, v56
  v_exp_f32 v57, v57
  v_exp_f32 v58, v58
  v_exp_f32 v59, v59
  s_waitcnt lgkmcnt(3)
  v_mfma_f32_32x32x8bf16_1k v[8:23], v[128:129], v[112:113], v[8:23]
  v_exp_f32 v60, v60
  v_exp_f32 v61, v61
  v_exp_f32 v62, v62
  v_exp_f32 v63, v63
  v_smfmac_f32_32x32x32_bf16 v[72:87], v[144:147], v[48:55], v148
  v_exp_f32 v64, v64
  v_exp_f32 v65, v65
  v_exp_f32 v66, v66
  v_exp_f32 v67, v67
  v_smfmac_f32_32x32x32_bf16 v[88:103], v[136:139], v[56:63], v148
  v_exp_f32 v68, v68
  v_exp_f32 v69, v69
  v_exp_f32 v70, v70
  v_exp_f32 v71, v71
  v_add_u32 v149, 4096, v149
  v_add_u32 v150, 2048, v150
  v_add_u32 v151, 10240, v151
  s_add_u32 s26, s26, 1
  s_cmp_lt_u32 s26, 4
  s_cbranch_scc1 k2_kernel_loop
  v_smfmac_f32_32x32x32_bf16 v[88:103], v[144:147], v[64:71], v148
  s_waitcnt lgkmcnt(0)
  s_nop 7
  s_nop 7
  v_mov_b32 v154, 0
  v_mov_b32 v155, 0
  s_mov_b32 s14, 0
  s_mov_b32 s15, 0
  v_pk_fma_f32 v[154:155], v[72:73], s[14:15], v[154:155]
  v_pk_fma_f32 v[154:155], v[74:75], s[14:15], v[154:155]
  v_pk_fma_f32 v[154:155], v[76:77], s[14:15], v[154:155]
  v_pk_fma_f32 v[154:155], v[78:79], s[14:15], v[154:155]
  v_pk_fma_f32 v[154:155], v[80:81], s[14:15], v[154:155]
  v_pk_fma_f32 v[154:155], v[82:83], s[14:15], v[154:155]
  v_pk_fma_f32 v[154:155], v[88:89], s[14:15], v[154:155]
  v_pk_fma_f32 v[154:155], v[90:91], s[14:15], v[154:155]
  v_pk_fma_f32 v[154:155], v[92:93], s[14:15], v[154:155]
  v_pk_fma_f32 v[154:155], v[94:95], s[14:15], v[154:155]
  v_pk_fma_f32 v[154:155], v[96:97], s[14:15], v[154:155]
  v_pk_fma_f32 v[154:155], v[98:99], s[14:15], v[154:155]
  v_add_f32 v154, v154, v155
  v_cmp_u_f32 s[16:17], v154, v154
  s_mov_b32 s14, 0x33800000
  s_mov_b32 s15, 0x71800000
  v_min_f32 v156, v80, v96
  v_max_f32 v157, v80, v96
  v_cmp_gt_f32 s[18:19], s14, v156
  v_cmp_lt_f32 vcc, s15, v157
  s_nop 1
  s_or_b64 s[18:19], s[18:19], vcc
  s_and_b32 s18, s18, 0
  s_or_b64 s[16:17], s[16:17], s[18:19]
  s_cmp_lg_u64 s[16:17], 0
  s_cbranch_scc1 k2_kernel_fb
k2_kernel_ok:
  s_cmp_eq_u32 s54, 0
  s_cbranch_scc1 k2_kernel_slowpoll
k2_kernel_ok2:
  s_setprio 0
  s_barrier
  s_lshr_b32 s61, s21, 4
  s_mov_b32 s62, s22
  s_mul_i32 s32, s22, 0
  s_and_b32 s14, s21, 15
  s_lshr_b32 s33, s14, 1
  s_lshl_b32 s14, s14, 7
  s_lshl_b32 s15, s20, 5
  s_add_u32 s63, s14, s15
  s_mov_b32 s92, s12
  s_mov_b32 s93, s13
  s_mov_b32 s94, 0x500000
  s_mov_b32 s95, 0x00020000
  s_mov_b32 s14, 22937600
  buffer_load_dwordx4 v[120:123], v199, s[28:31], s14 offen offset:0
  buffer_load_dwordx4 v[124:127], v199, s[28:31], s14 offen offset:1024
  buffer_load_dwordx4 v[128:131], v199, s[28:31], s14 offen offset:2048
  buffer_load_dwordx4 v[132:135], v199, s[28:31], s14 offen offset:3072
  s_mov_b32 s14, 22941696
  buffer_load_dwordx4 v[136:139], v199, s[28:31], s14 offen
  s_lshl_b32 s14, s20, 12
  v_add_u32 v2, s14, v199
  v_lshl_add_u32 v3, v1, 2, s14
  s_cmp_eq_u32 s23, 0
  s_cbranch_scc1 k2_kernel_snd0
  ds_write_b128 v2, v[72:75] offset:0
  ds_write_b128 v2, v[76:79] offset:1024
  ds_write_b128 v2, v[80:83] offset:2048
  ds_write_b32 v3, v152 offset:3072
  s_branch k2_kernel_snd1
k2_kernel_snd0:
  ds_write_b128 v2, v[88:91] offset:0
  ds_write_b128 v2, v[92:95] offset:1024
  ds_write_b128 v2, v[96:99] offset:2048
  ds_write_b32 v3, v153 offset:3072
k2_kernel_snd1:
  v_mov_b32 v4, s54
  s_lshl_b32 s14, s20, 2
  v_mov_b32 v5, s14
  ds_write_b32 v5, v4 offset:36864
  s_waitcnt vmcnt(5)
  v_add_f32 v182, v182, v183
  v_add_f32 v190, v190, v191
  v_add_f32 v182, v182, v184
  v_add_f32 v190, v190, v192
  v_add_f32 v182, v182, v185
  v_add_f32 v190, v190, v193
  v_add_f32 v182, v182, v186
  v_add_f32 v190, v190, v194
  v_add_f32 v182, v182, v187
  v_add_f32 v190, v190, v195
  v_add_f32 v182, v182, v188
  v_add_f32 v190, v190, v196
  v_add_f32 v182, v182, v189
  v_add_f32 v190, v190, v197
  v_cvt_pk_bf16_f32 v182, v182, v182
  v_cvt_pk_bf16_f32 v190, v190, v190
  ds_write_b16 v236, v182 offset:32768
  ds_write_b16 v237, v190 offset:32768
  s_waitcnt lgkmcnt(0)
  s_barrier
  v_xor_b32 v2, 16384, v2
  v_xor_b32 v3, 16384, v3
  s_cmp_eq_u32 s23, 0
  s_cbranch_scc1 k2_kernel_rcv0
  ds_read_b128 v[72:75], v2 offset:0
  ds_read_b128 v[76:79], v2 offset:1024
  ds_read_b128 v[80:83], v2 offset:2048
  ds_read_b32 v152, v3 offset:3072
  s_branch k2_kernel_rcv1
k2_kernel_rcv0:
  ds_read_b128 v[88:91], v2 offset:0
  ds_read_b128 v[92:95], v2 offset:1024
  ds_read_b128 v[96:99], v2 offset:2048
  ds_read_b32 v153, v3 offset:3072
k2_kernel_rcv1:
  v_and_b32 v4, 7, v1
  v_lshlrev_b32 v4, 2, v4
  ds_read_b32 v198, v4 offset:36864
  ds_read_b128 v[8:11], v238 offset:32768
  ds_read_b128 v[12:15], v238 offset:32784
  ds_read_b128 v[16:19], v238 offset:32800
  v_mul_u32_u24 v200, 33024, v7
  v_lshl_add_u32 v200, v6, 4, v200
  v_cmp_gt_u32 vcc, 32, v1
  v_lshlrev_b32 v201, 3, v6
  v_mov_b32 v154, 0x40000000
  v_cndmask_b32 v201, v154, v201, vcc
  s_lshl_b32 s14, s23, 5
  s_add_u32 s44, s14, s46
  s_waitcnt lgkmcnt(0)
  v_max_f32 v154, v152, v153
  v_sub_f32 v155, v152, v154
  v_sub_f32 v156, v153, v154
  v_exp_f32 v156, v156
  v_exp_f32 v154, v155
  s_nop 0
  v_mov_b32 v157, v156
  v_mov_b32 v155, v154
  v_pk_mul_f32 v[72:73], v[72:73], v[154:155]
  v_pk_mul_f32 v[74:75], v[74:75], v[154:155]
  v_pk_mul_f32 v[76:77], v[76:77], v[154:155]
  v_pk_mul_f32 v[78:79], v[78:79], v[154:155]
  v_pk_mul_f32 v[80:81], v[80:81], v[154:155]
  v_pk_mul_f32 v[82:83], v[82:83], v[154:155]
  v_pk_fma_f32 v[72:73], v[88:89], v[156:157], v[72:73]
  v_pk_fma_f32 v[74:75], v[90:91], v[156:157], v[74:75]
  v_pk_fma_f32 v[76:77], v[92:93], v[156:157], v[76:77]
  v_pk_fma_f32 v[78:79], v[94:95], v[156:157], v[78:79]
  v_pk_fma_f32 v[80:81], v[96:97], v[156:157], v[80:81]
  v_pk_fma_f32 v[82:83], v[98:99], v[156:157], v[82:83]
  v_mov_b32 v154, v80
  v_mov_b32 v155, v80
  s_mul_i32 s14, s21, 66048
  s_lshl_b32 s15, s44, 4
  v_permlane32_swap_b32 v154, v155
  s_add_u32 s14, s14, s15
  s_add_u32 s14, s14, 16777216
  v_rcp_f32 v155, v155
  s_mul_i32 s15, s21, 16640
  s_lshl_b32 s16, s44, 3
  v_mov_b32 v154, v155
  v_pk_mul_f32 v[72:73], v[72:73], v[154:155]
  v_pk_mul_f32 v[74:75], v[74:75], v[154:155]
  v_pk_mul_f32 v[76:77], v[76:77], v[154:155]
  v_pk_mul_f32 v[78:79], v[78:79], v[154:155]
  v_pk_mul_f32 v[80:81], v[80:81], v[154:155]
  v_pk_mul_f32 v[82:83], v[82:83], v[154:155]
  v_cvt_pk_bf16_f32 v88, v72, v73
  v_cvt_pk_bf16_f32 v89, v74, v75
  v_cvt_pk_bf16_f32 v90, v76, v77
  v_cvt_pk_bf16_f32 v91, v78, v79
  v_cvt_pk_bf16_f32 v92, v80, v81
  v_cvt_pk_bf16_f32 v93, v82, v83
  s_add_u32 s15, s15, s16
  s_add_u32 s15, s15, 18939904
  v_permlane32_swap_b32 v88, v90
  v_permlane32_swap_b32 v89, v91
  buffer_store_dwordx2 v[92:93], v201, s[28:31], s15 offen sc1
  buffer_store_dwordx4 v[88:91], v200, s[28:31], s14 offen sc1
  v_cmp_eq_u32 vcc, 2, v198
  s_nop 1
  s_cmp_lg_u64 vcc, 0
  s_cbranch_scc1 k2_kernel_recompute
k2_kernel_bmfma:
  v_mfma_f32_32x32x16_bf16 v[40:55], v[8:11], v[170:173], 0
  v_mfma_f32_32x32x16_bf16 v[40:55], v[12:15], v[174:177], v[40:55]
  v_mfma_f32_32x32x16_bf16 v[40:55], v[16:19], v[178:181], v[40:55]
  s_nop 7
  s_nop 3
  v_mov_b32 v154, v48
  v_mov_b32 v155, v48
  s_mul_i32 s14, s21, 66048
  s_lshl_b32 s15, s49, 4
  v_permlane32_swap_b32 v154, v155
  s_add_u32 s14, s14, s15
  s_add_u32 s14, s14, 19529728
  v_add_f32 v155, 0x358637bd, v155
  v_rcp_f32 v155, v155
  s_mul_i32 s15, s21, 16640
  s_lshl_b32 s16, s49, 3
  v_mov_b32 v154, v155
  v_pk_mul_f32 v[40:41], v[40:41], v[154:155]
  v_pk_mul_f32 v[42:43], v[42:43], v[154:155]
  v_pk_mul_f32 v[44:45], v[44:45], v[154:155]
  v_pk_mul_f32 v[46:47], v[46:47], v[154:155]
  v_pk_mul_f32 v[48:49], v[48:49], v[154:155]
  v_pk_mul_f32 v[50:51], v[50:51], v[154:155]
  v_cvt_pk_bf16_f32 v24, v40, v41
  v_cvt_pk_bf16_f32 v25, v42, v43
  v_cvt_pk_bf16_f32 v26, v44, v45
  v_cvt_pk_bf16_f32 v27, v46, v47
  v_cvt_pk_bf16_f32 v28, v48, v49
  v_cvt_pk_bf16_f32 v29, v50, v51
  s_add_u32 s15, s15, s16
  s_add_u32 s15, s15, 21692416
  v_permlane32_swap_b32 v24, v26
  v_permlane32_swap_b32 v25, v27
  buffer_store_dwordx2 v[28:29], v201, s[28:31], s15 offen sc1
  buffer_store_dwordx4 v[24:27], v200, s[28:31], s14 offen sc1
  s_waitcnt vmcnt(4)
  s_add_u32 s16, s20, 0
  s_add_u32 s14, s16, s32
  s_and_b32 s14, s14, 15
  s_mul_i32 s14, s14, 51200
  s_mul_i32 s15, s62, 160
  s_add_u32 s14, s14, s15
  s_mul_i32 s16, s16, 5120
  s_add_u32 m0, s16, 40960
  s_nop 0
  buffer_load_dwordx4 v120, s[36:39], s14 offen offset:0 lds
  buffer_load_dwordx4 v121, s[36:39], s14 offen offset:1024 lds
  buffer_load_dwordx4 v122, s[36:39], s14 offen offset:2048 lds
  buffer_load_dwordx4 v123, s[36:39], s14 offen offset:3072 lds
  s_add_u32 m0, m0, 4096
  s_nop 0
  buffer_load_dwordx4 v124, s[36:39], s14 offen lds
  s_waitcnt vmcnt(5)
  s_barrier
  s_cmp_lg_u32 s20, 0
  s_cbranch_scc1 k2_kernel_o_nopub
  s_lshl_b32 s14, s22, 5
  s_add_u32 s14, s14, s21
  s_lshl_b32 s14, s14, 7
  s_add_u32 s14, s14, 22872064
  s_add_u32 s15, s35, 1
  v_mov_b32 v2, s15
  v_mov_b32 v3, 0
  s_mov_b64 exec, 1
  buffer_store_dword v2, v3, s[28:31], s14 offen sc1
  s_mov_b64 exec, -1
k2_kernel_o_nopub:
  s_add_u32 s16, s20, 8
  s_add_u32 s14, s16, s32
  s_and_b32 s14, s14, 15
  s_mul_i32 s14, s14, 51200
  s_mul_i32 s15, s62, 160
  s_add_u32 s14, s14, s15
  s_mul_i32 s16, s16, 5120
  s_add_u32 m0, s16, 40960
  s_nop 0
  buffer_load_dwordx4 v120, s[36:39], s14 offen offset:0 lds
  buffer_load_dwordx4 v121, s[36:39], s14 offen offset:1024 lds
  buffer_load_dwordx4 v122, s[36:39], s14 offen offset:2048 lds
  buffer_load_dwordx4 v123, s[36:39], s14 offen offset:3072 lds
  s_add_u32 m0, m0, 4096
  s_nop 0
  buffer_load_dwordx4 v124, s[36:39], s14 offen lds
  s_cmp_ge_u32 s20, 4
  s_cbranch_scc1 k2_kernel_w3skip2
  s_add_u32 s16, s20, 16
  s_mul_i32 s14, s20, 204800
  s_mul_i32 s15, s62, 160
  s_add_u32 s14, s14, s15
  s_mul_i32 s16, s16, 5120
  s_add_u32 m0, s16, 40960
  s_nop 0
  buffer_load_dwordx4 v125, s[36:39], s14 offen offset:0 lds
  buffer_load_dwordx4 v126, s[36:39], s14 offen offset:1024 lds
  buffer_load_dwordx4 v127, s[36:39], s14 offen offset:2048 lds
  buffer_load_dwordx4 v128, s[36:39], s14 offen offset:3072 lds
  s_add_u32 m0, m0, 4096
  s_nop 0
  buffer_load_dwordx4 v129, s[36:39], s14 offen lds
k2_kernel_w3skip2:
  v_lshlrev_b32 v3, 7, v6
  s_lshl_b32 s42, s33, 12
  s_add_u32 s42, s42, 22872064
  v_add_u32 v155, 51200, v137
  s_mul_i32 s16, s20, 5120
  s_add_u32 s16, s16, 143360
  v_add_u32 v138, s16, v138
  v_add_u32 v158, s16, v199
  s_cmp_lg_u32 s20, 0
  s_cbranch_scc1 k2_kernel_op2
  s_mov_b32 s26, 0
k2_kernel_op1:
  buffer_load_dword v198, v3, s[28:31], s42 offen sc1
  s_waitcnt vmcnt(0)
  v_cmp_eq_u32 vcc, v198, v243
  s_add_u32 s26, s26, 1
  s_nop 0
  s_cmp_eq_u64 vcc, 0
  s_cbranch_scc1 k2_kernel_op2
  s_sleep 1
  s_cmp_lt_u32 s26, 100000
  s_cbranch_scc1 k2_kernel_op1
k2_kernel_op2:
  s_waitcnt vmcnt(0)
  s_barrier
  s_cmp_ge_u32 s20, 4
  s_cbranch_scc1 k2_kernel_p3done
  s_mul_i32 s15, s61, 2752512
  s_add_u32 s15, s15, 16777216
  s_lshl_b32 s14, s63, 4
  s_add_u32 s14, s14, s15
  s_mov_b32 s17, s32
  s_lshl_b32 s18, s63, 3
  s_add_u32 s18, s18, s15
  s_add_u32 s18, s18, 2162688
  s_mul_i32 s16, s17, 132096
  s_add_u32 s16, s16, s14
  buffer_load_dwordx4 v[8:11], v130, s[28:31], s16 offen offset:0 sc1
  buffer_load_dwordx4 v[12:15], v130, s[28:31], s16 offen offset:256 sc1
  s_add_u32 s17, s17, 1
  s_and_b32 s17, s17, 15
  s_mul_i32 s16, s17, 132096
  s_add_u32 s16, s16, s14
  buffer_load_dwordx4 v[16:19], v130, s[28:31], s16 offen offset:0 sc1
  buffer_load_dwordx4 v[20:23], v130, s[28:31], s16 offen offset:256 sc1
  s_add_u32 s17, s17, 1
  s_and_b32 s17, s17, 15
  s_mul_i32 s16, s17, 132096
  s_add_u32 s16, s16, s14
  buffer_load_dwordx4 v[24:27], v130, s[28:31], s16 offen offset:0 sc1
  buffer_load_dwordx4 v[28:31], v130, s[28:31], s16 offen offset:256 sc1
  s_add_u32 s17, s17, 1
  s_and_b32 s17, s17, 15
  s_mul_i32 s16, s17, 132096
  s_add_u32 s16, s16, s14
  buffer_load_dwordx4 v[32:35], v130, s[28:31], s16 offen offset:0 sc1
  buffer_load_dwordx4 v[36:39], v130, s[28:31], s16 offen offset:256 sc1
  s_add_u32 s17, s17, 1
  s_and_b32 s17, s17, 15
  s_mul_i32 s16, s17, 132096
  s_add_u32 s16, s16, s14
  buffer_load_dwordx4 v[40:43], v130, s[28:31], s16 offen offset:0 sc1
  buffer_load_dwordx4 v[44:47], v130, s[28:31], s16 offen offset:256 sc1
  s_add_u32 s17, s17, 1
  s_and_b32 s17, s17, 15
  ds_read_b64_tr_b16 v[204:205], v137 offset:0
  ds_read_b64_tr_b16 v[206:207], v137 offset:1280
  ds_read_b64_tr_b16 v[208:209], v137 offset:32
  ds_read_b64_tr_b16 v[210:211], v137 offset:1312
  ds_read_b64_tr_b16 v[212:213], v137 offset:64
  ds_read_b64_tr_b16 v[214:215], v137 offset:1344
  ds_read_b64_tr_b16 v[216:217], v137 offset:96
  ds_read_b64_tr_b16 v[218:219], v137 offset:1376
  ds_read_b64_tr_b16 v[220:221], v137 offset:128
  ds_read_b64_tr_b16 v[222:223], v137 offset:1408
  ds_read_b64_tr_b16 v[224:225], v137 offset:5120
  ds_read_b64_tr_b16 v[226:227], v137 offset:6400
  ds_read_b64_tr_b16 v[228:229], v137 offset:5152
  ds_read_b64_tr_b16 v[230:231], v137 offset:6432
  s_waitcnt vmcnt(8)
  s_waitcnt lgkmcnt(12)
  v_mfma_f32_16x16x32_bf16 v[72:75], v[204:207], v[8:11], 0
  v_mfma_f32_16x16x32_bf16 v[92:95], v[204:207], v[12:15], 0
  ds_read_b64_tr_b16 v[232:233], v137 offset:5184
  ds_read_b64_tr_b16 v[234:235], v137 offset:6464
  s_waitcnt lgkmcnt(12)
  v_mfma_f32_16x16x32_bf16 v[76:79], v[208:211], v[8:11], 0
  v_mfma_f32_16x16x32_bf16 v[96:99], v[208:211], v[12:15], 0
  s_mul_i32 s16, s17, 132096
  s_add_u32 s16, s16, s14
  buffer_load_dwordx4 v[48:51], v130, s[28:31], s16 offen offset:0 sc1
  buffer_load_dwordx4 v[52:55], v130, s[28:31], s16 offen offset:256 sc1
  s_add_u32 s17, s17, 1
  s_and_b32 s17, s17, 15
  ds_read_b64_tr_b16 v[204:205], v137 offset:5216
  ds_read_b64_tr_b16 v[206:207], v137 offset:6496
  s_waitcnt lgkmcnt(12)
  v_mfma_f32_16x16x32_bf16 v[80:83], v[212:215], v[8:11], 0
  v_mfma_f32_16x16x32_bf16 v[100:103], v[212:215], v[12:15], 0
  ds_read_b64_tr_b16 v[208:209], v137 offset:5248
  ds_read_b64_tr_b16 v[210:211], v137 offset:6528
  s_waitcnt lgkmcnt(12)
  v_mfma_f32_16x16x32_bf16 v[84:87], v[216:219], v[8:11], 0
  v_mfma_f32_16x16x32_bf16 v[104:107], v[216:219], v[12:15], 0
  ds_read_b64_tr_b16 v[212:213], v137 offset:10240
  ds_read_b64_tr_b16 v[214:215], v137 offset:11520
  s_waitcnt lgkmcnt(12)
  v_mfma_f32_16x16x32_bf16 v[88:91], v[220:223], v[8:11], 0
  v_mfma_f32_16x16x32_bf16 v[108:111], v[220:223], v[12:15], 0
  ds_read_b64_tr_b16 v[216:217], v137 offset:10272
  ds_read_b64_tr_b16 v[218:219], v137 offset:11552
  s_waitcnt vmcnt(8)
  s_waitcnt lgkmcnt(12)
  v_mfma_f32_16x16x32_bf16 v[72:75], v[224:227], v[16:19], v[72:75]
  v_mfma_f32_16x16x32_bf16 v[92:95], v[224:227], v[20:23], v[92:95]
  ds_read_b64_tr_b16 v[220:221], v137 offset:10304
  ds_read_b64_tr_b16 v[222:223], v137 offset:11584
  s_waitcnt lgkmcnt(12)
  v_mfma_f32_16x16x32_bf16 v[76:79], v[228:231], v[16:19], v[76:79]
  v_mfma_f32_16x16x32_bf16 v[96:99], v[228:231], v[20:23], v[96:99]
  s_mul_i32 s16, s17, 132096
  s_add_u32 s16, s16, s14
  buffer_load_dwordx4 v[56:59], v130, s[28:31], s16 offen offset:0 sc1
  buffer_load_dwordx4 v[60:63], v130, s[28:31], s16 offen offset:256 sc1
  s_add_u32 s17, s17, 1
  s_and_b32 s17, s17, 15
  ds_read_b64_tr_b16 v[224:225], v137 offset:10336
  ds_read_b64_tr_b16 v[226:227], v137 offset:11616
  s_waitcnt lgkmcnt(12)
  v_mfma_f32_16x16x32_bf16 v[80:83], v[232:235], v[16:19], v[80:83]
  v_mfma_f32_16x16x32_bf16 v[100:103], v[232:235], v[20:23], v[100:103]
  ds_read_b64_tr_b16 v[228:229], v137 offset:10368
  ds_read_b64_tr_b16 v[230:231], v137 offset:11648
  s_waitcnt lgkmcnt(12)
  v_mfma_f32_16x16x32_bf16 v[84:87], v[204:207], v[16:19], v[84:87]
  v_mfma_f32_16x16x32_bf16 v[104:107], v[204:207], v[20:23], v[104:107]
  ds_read_b64_tr_b16 v[232:233], v137 offset:15360
  ds_read_b64_tr_b16 v[234:235], v137 offset:16640
  s_waitcnt lgkmcnt(12)
  v_mfma_f32_16x16x32_bf16 v[88:91], v[208:211], v[16:19], v[88:91]
  v_mfma_f32_16x16x32_bf16 v[108:111], v[208:211], v[20:23], v[108:111]
  ds_read_b64_tr_b16 v[204:205], v137 offset:15392
  ds_read_b64_tr_b16 v[206:207], v137 offset:16672
  s_waitcnt vmcnt(8)
  s_waitcnt lgkmcnt(12)
  v_mfma_f32_16x16x32_bf16 v[72:75], v[212:215], v[24:27], v[72:75]
  v_mfma_f32_16x16x32_bf16 v[92:95], v[212:215], v[28:31], v[92:95]
  ds_read_b64_tr_b16 v[208:209], v137 offset:15424
  ds_read_b64_tr_b16 v[210:211], v137 offset:16704
  s_waitcnt lgkmcnt(12)
  v_mfma_f32_16x16x32_bf16 v[76:79], v[216:219], v[24:27], v[76:79]
  v_mfma_f32_16x16x32_bf16 v[96:99], v[216:219], v[28:31], v[96:99]
  s_mul_i32 s16, s17, 132096
  s_add_u32 s16, s16, s14
  buffer_load_dwordx4 v[64:67], v130, s[28:31], s16 offen offset:0 sc1
  buffer_load_dwordx4 v[68:71], v130, s[28:31], s16 offen offset:256 sc1
  s_add_u32 s17, s17, 1
  s_and_b32 s17, s17, 15
  ds_read_b64_tr_b16 v[212:213], v137 offset:15456
  ds_read_b64_tr_b16 v[214:215], v137 offset:16736
  s_waitcnt lgkmcnt(12)
  v_mfma_f32_16x16x32_bf16 v[80:83], v[220:223], v[24:27], v[80:83]
  v_mfma_f32_16x16x32_bf16 v[100:103], v[220:223], v[28:31], v[100:103]
  ds_read_b64_tr_b16 v[216:217], v137 offset:15488
  ds_read_b64_tr_b16 v[218:219], v137 offset:16768
  s_waitcnt lgkmcnt(12)
  v_mfma_f32_16x16x32_bf16 v[84:87], v[224:227], v[24:27], v[84:87]
  v_mfma_f32_16x16x32_bf16 v[104:107], v[224:227], v[28:31], v[104:107]
  ds_read_b64_tr_b16 v[220:221], v137 offset:20480
  ds_read_b64_tr_b16 v[222:223], v137 offset:21760
  s_waitcnt lgkmcnt(12)
  v_mfma_f32_16x16x32_bf16 v[88:91], v[228:231], v[24:27], v[88:91]
  v_mfma_f32_16x16x32_bf16 v[108:111], v[228:231], v[28:31], v[108:111]
  ds_read_b64_tr_b16 v[224:225], v137 offset:20512
  ds_read_b64_tr_b16 v[226:227], v137 offset:21792
  s_waitcnt vmcnt(8)
  s_waitcnt lgkmcnt(12)
  v_mfma_f32_16x16x32_bf16 v[72:75], v[232:235], v[32:35], v[72:75]
  v_mfma_f32_16x16x32_bf16 v[92:95], v[232:235], v[36:39], v[92:95]
  ds_read_b64_tr_b16 v[228:229], v137 offset:20544
  ds_read_b64_tr_b16 v[230:231], v137 offset:21824
  s_waitcnt lgkmcnt(12)
  v_mfma_f32_16x16x32_bf16 v[76:79], v[204:207], v[32:35], v[76:79]
  v_mfma_f32_16x16x32_bf16 v[96:99], v[204:207], v[36:39], v[96:99]
  s_mul_i32 s16, s17, 132096
  s_add_u32 s16, s16, s14
  buffer_load_dwordx4 v[8:11], v130, s[28:31], s16 offen offset:0 sc1
  buffer_load_dwordx4 v[12:15], v130, s[28:31], s16 offen offset:256 sc1
  s_add_u32 s17, s17, 1
  s_and_b32 s17, s17, 15
  ds_read_b64_tr_b16 v[232:233], v137 offset:20576
  ds_read_b64_tr_b16 v[234:235], v137 offset:21856
  s_waitcnt lgkmcnt(12)
  v_mfma_f32_16x16x32_bf16 v[80:83], v[208:211], v[32:35], v[80:83]
  v_mfma_f32_16x16x32_bf16 v[100:103], v[208:211], v[36:39], v[100:103]
  ds_read_b64_tr_b16 v[204:205], v137 offset:20608
  ds_read_b64_tr_b16 v[206:207], v137 offset:21888
  s_waitcnt lgkmcnt(12)
  v_mfma_f32_16x16x32_bf16 v[84:87], v[212:215], v[32:35], v[84:87]
  v_mfma_f32_16x16x32_bf16 v[104:107], v[212:215], v[36:39], v[104:107]
  ds_read_b64_tr_b16 v[208:209], v137 offset:25600
  ds_read_b64_tr_b16 v[210:211], v137 offset:26880
  s_waitcnt lgkmcnt(12)
  v_mfma_f32_16x16x32_bf16 v[88:91], v[216:219], v[32:35], v[88:91]
  v_mfma_f32_16x16x32_bf16 v[108:111], v[216:219], v[36:39], v[108:111]
  ds_read_b64_tr_b16 v[212:213], v137 offset:25632
  ds_read_b64_tr_b16 v[214:215], v137 offset:26912
  s_waitcnt vmcnt(8)
  s_waitcnt lgkmcnt(12)
  v_mfma_f32_16x16x32_bf16 v[72:75], v[220:223], v[40:43], v[72:75]
  v_mfma_f32_16x16x32_bf16 v[92:95], v[220:223], v[44:47], v[92:95]
  ds_read_b64_tr_b16 v[216:217], v137 offset:25664
  ds_read_b64_tr_b16 v[218:219], v137 offset:26944
  s_waitcnt lgkmcnt(12)
  v_mfma_f32_16x16x32_bf16 v[76:79], v[224:227], v[40:43], v[76:79]
  v_mfma_f32_16x16x32_bf16 v[96:99], v[224:227], v[44:47], v[96:99]
  s_mul_i32 s16, s17, 132096
  s_add_u32 s16, s16, s14
  buffer_load_dwordx4 v[16:19], v130, s[28:31], s16 offen offset:0 sc1
  buffer_load_dwordx4 v[20:23], v130, s[28:31], s16 offen offset:256 sc1
  s_add_u32 s17, s17, 1
  s_and_b32 s17, s17, 15
  ds_read_b64_tr_b16 v[220:221], v137 offset:25696
  ds_read_b64_tr_b16 v[222:223], v137 offset:26976
  s_waitcnt lgkmcnt(12)
  v_mfma_f32_16x16x32_bf16 v[80:83], v[228:231], v[40:43], v[80:83]
  v_mfma_f32_16x16x32_bf16 v[100:103], v[228:231], v[44:47], v[100:103]
  ds_read_b64_tr_b16 v[224:225], v137 offset:25728
  ds_read_b64_tr_b16 v[226:227], v137 offset:27008
  s_waitcnt lgkmcnt(12)
  v_mfma_f32_16x16x32_bf16 v[84:87], v[232:235], v[40:43], v[84:87]
  v_mfma_f32_16x16x32_bf16 v[104:107], v[232:235], v[44:47], v[104:107]
  ds_read_b64_tr_b16 v[228:229], v137 offset:30720
  ds_read_b64_tr_b16 v[230:231], v137 offset:32000
  s_waitcnt lgkmcnt(12)
  v_mfma_f32_16x16x32_bf16 v[88:91], v[204:207], v[40:43], v[88:91]
  v_mfma_f32_16x16x32_bf16 v[108:111], v[204:207], v[44:47], v[108:111]
  ds_read_b64_tr_b16 v[232:233], v137 offset:30752
  ds_read_b64_tr_b16 v[234:235], v137 offset:32032
  s_waitcnt vmcnt(8)
  s_waitcnt lgkmcnt(12)
  v_mfma_f32_16x16x32_bf16 v[72:75], v[208:211], v[48:51], v[72:75]
  v_mfma_f32_16x16x32_bf16 v[92:95], v[208:211], v[52:55], v[92:95]
  ds_read_b64_tr_b16 v[204:205], v137 offset:30784
  ds_read_b64_tr_b16 v[206:207], v137 offset:32064
  s_waitcnt lgkmcnt(12)
  v_mfma_f32_16x16x32_bf16 v[76:79], v[212:215], v[48:51], v[76:79]
  v_mfma_f32_16x16x32_bf16 v[96:99], v[212:215], v[52:55], v[96:99]
  s_mul_i32 s16, s17, 132096
  s_add_u32 s16, s16, s14
  buffer_load_dwordx4 v[24:27], v130, s[28:31], s16 offen offset:0 sc1
  buffer_load_dwordx4 v[28:31], v130, s[28:31], s16 offen offset:256 sc1
  s_add_u32 s17, s17, 1
  s_and_b32 s17, s17, 15
  ds_read_b64_tr_b16 v[208:209], v137 offset:30816
  ds_read_b64_tr_b16 v[210:211], v137 offset:32096
  s_waitcnt lgkmcnt(12)
  v_mfma_f32_16x16x32_bf16 v[80:83], v[216:219], v[48:51], v[80:83]
  v_mfma_f32_16x16x32_bf16 v[100:103], v[216:219], v[52:55], v[100:103]
  ds_read_b64_tr_b16 v[212:213], v137 offset:30848
  ds_read_b64_tr_b16 v[214:215], v137 offset:32128
  s_waitcnt lgkmcnt(12)
  v_mfma_f32_16x16x32_bf16 v[84:87], v[220:223], v[48:51], v[84:87]
  v_mfma_f32_16x16x32_bf16 v[104:107], v[220:223], v[52:55], v[104:107]
  ds_read_b64_tr_b16 v[216:217], v137 offset:35840
  ds_read_b64_tr_b16 v[218:219], v137 offset:37120
  s_waitcnt lgkmcnt(12)
  v_mfma_f32_16x16x32_bf16 v[88:91], v[224:227], v[48:51], v[88:91]
  v_mfma_f32_16x16x32_bf16 v[108:111], v[224:227], v[52:55], v[108:111]
  ds_read_b64_tr_b16 v[220:221], v137 offset:35872
  ds_read_b64_tr_b16 v[222:223], v137 offset:37152
  s_waitcnt vmcnt(8)
  s_waitcnt lgkmcnt(12)
  v_mfma_f32_16x16x32_bf16 v[72:75], v[228:231], v[56:59], v[72:75]
  v_mfma_f32_16x16x32_bf16 v[92:95], v[228:231], v[60:63], v[92:95]
  ds_read_b64_tr_b16 v[224:225], v137 offset:35904
  ds_read_b64_tr_b16 v[226:227], v137 offset:37184
  s_waitcnt lgkmcnt(12)
  v_mfma_f32_16x16x32_bf16 v[76:79], v[232:235], v[56:59], v[76:79]
  v_mfma_f32_16x16x32_bf16 v[96:99], v[232:235], v[60:63], v[96:99]
  s_mul_i32 s16, s17, 132096
  s_add_u32 s16, s16, s14
  buffer_load_dwordx4 v[32:35], v130, s[28:31], s16 offen offset:0 sc1
  buffer_load_dwordx4 v[36:39], v130, s[28:31], s16 offen offset:256 sc1
  s_add_u32 s17, s17, 1
  s_and_b32 s17, s17, 15
  ds_read_b64_tr_b16 v[228:229], v137 offset:35936
  ds_read_b64_tr_b16 v[230:231], v137 offset:37216
  s_waitcnt lgkmcnt(12)
  v_mfma_f32_16x16x32_bf16 v[80:83], v[204:207], v[56:59], v[80:83]
  v_mfma_f32_16x16x32_bf16 v[100:103], v[204:207], v[60:63], v[100:103]
  ds_read_b64_tr_b16 v[232:233], v137 offset:35968
  ds_read_b64_tr_b16 v[234:235], v137 offset:37248
  s_waitcnt lgkmcnt(12)
  v_mfma_f32_16x16x32_bf16 v[84:87], v[208:211], v[56:59], v[84:87]
  v_mfma_f32_16x16x32_bf16 v[104:107], v[208:211], v[60:63], v[104:107]
  ds_read_b64_tr_b16 v[204:205], v137 offset:40960
  ds_read_b64_tr_b16 v[206:207], v137 offset:42240
  s_waitcnt lgkmcnt(12)
  v_mfma_f32_16x16x32_bf16 v[88:91], v[212:215], v[56:59], v[88:91]
  v_mfma_f32_16x16x32_bf16 v[108:111], v[212:215], v[60:63], v[108:111]
  ds_read_b64_tr_b16 v[208:209], v137 offset:40992
  ds_read_b64_tr_b16 v[210:211], v137 offset:42272
  s_waitcnt vmcnt(8)
  s_waitcnt lgkmcnt(12)
  v_mfma_f32_16x16x32_bf16 v[72:75], v[216:219], v[64:67], v[72:75]
  v_mfma_f32_16x16x32_bf16 v[92:95], v[216:219], v[68:71], v[92:95]
  ds_read_b64_tr_b16 v[212:213], v137 offset:41024
  ds_read_b64_tr_b16 v[214:215], v137 offset:42304
  s_waitcnt lgkmcnt(12)
  v_mfma_f32_16x16x32_bf16 v[76:79], v[220:223], v[64:67], v[76:79]
  v_mfma_f32_16x16x32_bf16 v[96:99], v[220:223], v[68:71], v[96:99]
  s_mul_i32 s16, s17, 132096
  s_add_u32 s16, s16, s14
  buffer_load_dwordx4 v[40:43], v130, s[28:31], s16 offen offset:0 sc1
  buffer_load_dwordx4 v[44:47], v130, s[28:31], s16 offen offset:256 sc1
  s_add_u32 s17, s17, 1
  s_and_b32 s17, s17, 15
  ds_read_b64_tr_b16 v[216:217], v137 offset:41056
  ds_read_b64_tr_b16 v[218:219], v137 offset:42336
  s_waitcnt lgkmcnt(12)
  v_mfma_f32_16x16x32_bf16 v[80:83], v[224:227], v[64:67], v[80:83]
  v_mfma_f32_16x16x32_bf16 v[100:103], v[224:227], v[68:71], v[100:103]
  ds_read_b64_tr_b16 v[220:221], v137 offset:41088
  ds_read_b64_tr_b16 v[222:223], v137 offset:42368
  s_waitcnt lgkmcnt(12)
  v_mfma_f32_16x16x32_bf16 v[84:87], v[228:231], v[64:67], v[84:87]
  v_mfma_f32_16x16x32_bf16 v[104:107], v[228:231], v[68:71], v[104:107]
  ds_read_b64_tr_b16 v[224:225], v137 offset:46080
  ds_read_b64_tr_b16 v[226:227], v137 offset:47360
  s_waitcnt lgkmcnt(12)
  v_mfma_f32_16x16x32_bf16 v[88:91], v[232:235], v[64:67], v[88:91]
  v_mfma_f32_16x16x32_bf16 v[108:111], v[232:235], v[68:71], v[108:111]
  ds_read_b64_tr_b16 v[228:229], v137 offset:46112
  ds_read_b64_tr_b16 v[230:231], v137 offset:47392
  s_waitcnt vmcnt(8)
  s_waitcnt lgkmcnt(12)
  v_mfma_f32_16x16x32_bf16 v[72:75], v[204:207], v[8:11], v[72:75]
  v_mfma_f32_16x16x32_bf16 v[92:95], v[204:207], v[12:15], v[92:95]
  ds_read_b64_tr_b16 v[232:233], v137 offset:46144
  ds_read_b64_tr_b16 v[234:235], v137 offset:47424
  s_waitcnt lgkmcnt(12)
  v_mfma_f32_16x16x32_bf16 v[76:79], v[208:211], v[8:11], v[76:79]
  v_mfma_f32_16x16x32_bf16 v[96:99], v[208:211], v[12:15], v[96:99]
  s_mul_i32 s16, s17, 132096
  s_add_u32 s16, s16, s14
  buffer_load_dwordx4 v[48:51], v130, s[28:31], s16 offen offset:0 sc1
  buffer_load_dwordx4 v[52:55], v130, s[28:31], s16 offen offset:256 sc1
  s_add_u32 s17, s17, 1
  s_and_b32 s17, s17, 15
  ds_read_b64_tr_b16 v[204:205], v137 offset:46176
  ds_read_b64_tr_b16 v[206:207], v137 offset:47456
  s_waitcnt lgkmcnt(12)
  v_mfma_f32_16x16x32_bf16 v[80:83], v[212:215], v[8:11], v[80:83]
  v_mfma_f32_16x16x32_bf16 v[100:103], v[212:215], v[12:15], v[100:103]
  ds_read_b64_tr_b16 v[208:209], v137 offset:46208
  ds_read_b64_tr_b16 v[210:211], v137 offset:47488
  s_waitcnt lgkmcnt(12)
  v_mfma_f32_16x16x32_bf16 v[84:87], v[216:219], v[8:11], v[84:87]
  v_mfma_f32_16x16x32_bf16 v[104:107], v[216:219], v[12:15], v[104:107]
  ds_read_b64_tr_b16 v[212:213], v137 offset:51200
  ds_read_b64_tr_b16 v[214:215], v137 offset:52480
  s_waitcnt lgkmcnt(12)
  v_mfma_f32_16x16x32_bf16 v[88:91], v[220:223], v[8:11], v[88:91]
  v_mfma_f32_16x16x32_bf16 v[108:111], v[220:223], v[12:15], v[108:111]
  ds_read_b64_tr_b16 v[216:217], v137 offset:51232
  ds_read_b64_tr_b16 v[218:219], v137 offset:52512
  s_waitcnt vmcnt(8)
  s_waitcnt lgkmcnt(12)
  v_mfma_f32_16x16x32_bf16 v[72:75], v[224:227], v[16:19], v[72:75]
  v_mfma_f32_16x16x32_bf16 v[92:95], v[224:227], v[20:23], v[92:95]
  ds_read_b64_tr_b16 v[220:221], v137 offset:51264
  ds_read_b64_tr_b16 v[222:223], v137 offset:52544
  s_waitcnt lgkmcnt(12)
  v_mfma_f32_16x16x32_bf16 v[76:79], v[228:231], v[16:19], v[76:79]
  v_mfma_f32_16x16x32_bf16 v[96:99], v[228:231], v[20:23], v[96:99]
  s_mul_i32 s16, s17, 132096
  s_add_u32 s16, s16, s14
  buffer_load_dwordx4 v[56:59], v130, s[28:31], s16 offen offset:0 sc1
  buffer_load_dwordx4 v[60:63], v130, s[28:31], s16 offen offset:256 sc1
  s_add_u32 s17, s17, 1
  s_and_b32 s17, s17, 15
  ds_read_b64_tr_b16 v[224:225], v137 offset:51296
  ds_read_b64_tr_b16 v[226:227], v137 offset:52576
  s_waitcnt lgkmcnt(12)
  v_mfma_f32_16x16x32_bf16 v[80:83], v[232:235], v[16:19], v[80:83]
  v_mfma_f32_16x16x32_bf16 v[100:103], v[232:235], v[20:23], v[100:103]
  ds_read_b64_tr_b16 v[228:229], v137 offset:51328
  ds_read_b64_tr_b16 v[230:231], v137 offset:52608
  s_waitcnt lgkmcnt(12)
  v_mfma_f32_16x16x32_bf16 v[84:87], v[204:207], v[16:19], v[84:87]
  v_mfma_f32_16x16x32_bf16 v[104:107], v[204:207], v[20:23], v[104:107]
  ds_read_b64_tr_b16 v[232:233], v137 offset:56320
  ds_read_b64_tr_b16 v[234:235], v137 offset:57600
  s_waitcnt lgkmcnt(12)
  v_mfma_f32_16x16x32_bf16 v[88:91], v[208:211], v[16:19], v[88:91]
  v_mfma_f32_16x16x32_bf16 v[108:111], v[208:211], v[20:23], v[108:111]
  ds_read_b64_tr_b16 v[204:205], v137 offset:56352
  ds_read_b64_tr_b16 v[206:207], v137 offset:57632
  s_waitcnt vmcnt(8)
  s_waitcnt lgkmcnt(12)
  v_mfma_f32_16x16x32_bf16 v[72:75], v[212:215], v[24:27], v[72:75]
  v_mfma_f32_16x16x32_bf16 v[92:95], v[212:215], v[28:31], v[92:95]
  ds_read_b64_tr_b16 v[208:209], v137 offset:56384
  ds_read_b64_tr_b16 v[210:211], v137 offset:57664
  s_waitcnt lgkmcnt(12)
  v_mfma_f32_16x16x32_bf16 v[76:79], v[216:219], v[24:27], v[76:79]
  v_mfma_f32_16x16x32_bf16 v[96:99], v[216:219], v[28:31], v[96:99]
  s_mul_i32 s16, s17, 132096
  s_add_u32 s16, s16, s14
  buffer_load_dwordx4 v[64:67], v130, s[28:31], s16 offen offset:0 sc1
  buffer_load_dwordx4 v[68:71], v130, s[28:31], s16 offen offset:256 sc1
  s_add_u32 s17, s17, 1
  s_and_b32 s17, s17, 15
  ds_read_b64_tr_b16 v[212:213], v137 offset:56416
  ds_read_b64_tr_b16 v[214:215], v137 offset:57696
  s_waitcnt lgkmcnt(12)
  v_mfma_f32_16x16x32_bf16 v[80:83], v[220:223], v[24:27], v[80:83]
  v_mfma_f32_16x16x32_bf16 v[100:103], v[220:223], v[28:31], v[100:103]
  ds_read_b64_tr_b16 v[216:217], v137 offset:56448
  ds_read_b64_tr_b16 v[218:219], v137 offset:57728
  s_waitcnt lgkmcnt(12)
  v_mfma_f32_16x16x32_bf16 v[84:87], v[224:227], v[24:27], v[84:87]
  v_mfma_f32_16x16x32_bf16 v[104:107], v[224:227], v[28:31], v[104:107]
  ds_read_b64_tr_b16 v[220:221], v137 offset:61440
  ds_read_b64_tr_b16 v[222:223], v137 offset:62720
  s_waitcnt lgkmcnt(12)
  v_mfma_f32_16x16x32_bf16 v[88:91], v[228:231], v[24:27], v[88:91]
  v_mfma_f32_16x16x32_bf16 v[108:111], v[228:231], v[28:31], v[108:111]
  ds_read_b64_tr_b16 v[224:225], v137 offset:61472
  ds_read_b64_tr_b16 v[226:227], v137 offset:62752
  s_waitcnt vmcnt(8)
  s_waitcnt lgkmcnt(12)
  v_mfma_f32_16x16x32_bf16 v[72:75], v[232:235], v[32:35], v[72:75]
  v_mfma_f32_16x16x32_bf16 v[92:95], v[232:235], v[36:39], v[92:95]
  ds_read_b64_tr_b16 v[228:229], v137 offset:61504
  ds_read_b64_tr_b16 v[230:231], v137 offset:62784
  s_waitcnt lgkmcnt(12)
  v_mfma_f32_16x16x32_bf16 v[76:79], v[204:207], v[32:35], v[76:79]
  v_mfma_f32_16x16x32_bf16 v[96:99], v[204:207], v[36:39], v[96:99]
  s_add_u32 s16, s18, 16640
  buffer_load_dwordx2 v[8:9], v131, s[28:31], s18 offen offset:0 sc1
  buffer_load_dwordx2 v[10:11], v131, s[28:31], s16 offen offset:0 sc1
  buffer_load_dwordx2 v[12:13], v131, s[28:31], s18 offen offset:128 sc1
  buffer_load_dwordx2 v[14:15], v131, s[28:31], s16 offen offset:128 sc1
  s_add_u32 s18, s18, 133120
  ds_read_b64_tr_b16 v[232:233], v137 offset:61536
  ds_read_b64_tr_b16 v[234:235], v137 offset:62816
  s_waitcnt lgkmcnt(12)
  v_mfma_f32_16x16x32_bf16 v[80:83], v[208:211], v[32:35], v[80:83]
  v_mfma_f32_16x16x32_bf16 v[100:103], v[208:211], v[36:39], v[100:103]
  ds_read_b64_tr_b16 v[204:205], v137 offset:61568
  ds_read_b64_tr_b16 v[206:207], v137 offset:62848
  s_waitcnt lgkmcnt(12)
  v_mfma_f32_16x16x32_bf16 v[84:87], v[212:215], v[32:35], v[84:87]
  v_mfma_f32_16x16x32_bf16 v[104:107], v[212:215], v[36:39], v[104:107]
  ds_read_b64_tr_b16 v[208:209], v155 offset:15360
  ds_read_b64_tr_b16 v[210:211], v155 offset:16640
  s_waitcnt lgkmcnt(12)
  v_mfma_f32_16x16x32_bf16 v[88:91], v[216:219], v[32:35], v[88:91]
  v_mfma_f32_16x16x32_bf16 v[108:111], v[216:219], v[36:39], v[108:111]
  ds_read_b64_tr_b16 v[212:213], v155 offset:15392
  ds_read_b64_tr_b16 v[214:215], v155 offset:16672
  s_waitcnt vmcnt(10)
  s_waitcnt lgkmcnt(12)
  v_mfma_f32_16x16x32_bf16 v[72:75], v[220:223], v[40:43], v[72:75]
  v_mfma_f32_16x16x32_bf16 v[92:95], v[220:223], v[44:47], v[92:95]
  ds_read_b64_tr_b16 v[216:217], v155 offset:15424
  ds_read_b64_tr_b16 v[218:219], v155 offset:16704
  s_waitcnt lgkmcnt(12)
  v_mfma_f32_16x16x32_bf16 v[76:79], v[224:227], v[40:43], v[76:79]
  v_mfma_f32_16x16x32_bf16 v[96:99], v[224:227], v[44:47], v[96:99]
  s_add_u32 s16, s18, 16640
  buffer_load_dwordx2 v[16:17], v131, s[28:31], s18 offen offset:0 sc1
  buffer_load_dwordx2 v[18:19], v131, s[28:31], s16 offen offset:0 sc1
  buffer_load_dwordx2 v[20:21], v131, s[28:31], s18 offen offset:128 sc1
  buffer_load_dwordx2 v[22:23], v131, s[28:31], s16 offen offset:128 sc1
  s_add_u32 s18, s18, 133120
  ds_read_b64_tr_b16 v[220:221], v155 offset:15456
  ds_read_b64_tr_b16 v[222:223], v155 offset:16736
  s_waitcnt lgkmcnt(12)
  v_mfma_f32_16x16x32_bf16 v[80:83], v[228:231], v[40:43], v[80:83]
  v_mfma_f32_16x16x32_bf16 v[100:103], v[228:231], v[44:47], v[100:103]
  ds_read_b64_tr_b16 v[224:225], v155 offset:15488
  ds_read_b64_tr_b16 v[226:227], v155 offset:16768
  s_waitcnt lgkmcnt(12)
  v_mfma_f32_16x16x32_bf16 v[84:87], v[232:235], v[40:43], v[84:87]
  v_mfma_f32_16x16x32_bf16 v[104:107], v[232:235], v[44:47], v[104:107]
  ds_read_b64_tr_b16 v[228:229], v155 offset:20480
  ds_read_b64_tr_b16 v[230:231], v155 offset:21760
  s_waitcnt lgkmcnt(12)
  v_mfma_f32_16x16x32_bf16 v[88:91], v[204:207], v[40:43], v[88:91]
  v_mfma_f32_16x16x32_bf16 v[108:111], v[204:207], v[44:47], v[108:111]
  ds_read_b64_tr_b16 v[232:233], v155 offset:20512
  ds_read_b64_tr_b16 v[234:235], v155 offset:21792
  s_waitcnt vmcnt(12)
  s_waitcnt lgkmcnt(12)
  v_mfma_f32_16x16x32_bf16 v[72:75], v[208:211], v[48:51], v[72:75]
  v_mfma_f32_16x16x32_bf16 v[92:95], v[208:211], v[52:55], v[92:95]
  ds_read_b64_tr_b16 v[204:205], v155 offset:20544
  ds_read_b64_tr_b16 v[206:207], v155 offset:21824
  s_waitcnt lgkmcnt(12)
  v_mfma_f32_16x16x32_bf16 v[76:79], v[212:215], v[48:51], v[76:79]
  v_mfma_f32_16x16x32_bf16 v[96:99], v[212:215], v[52:55], v[96:99]
  s_add_u32 s16, s18, 16640
  buffer_load_dwordx2 v[24:25], v131, s[28:31], s18 offen offset:0 sc1
  buffer_load_dwordx2 v[26:27], v131, s[28:31], s16 offen offset:0 sc1
  buffer_load_dwordx2 v[28:29], v131, s[28:31], s18 offen offset:128 sc1
  buffer_load_dwordx2 v[30:31], v131, s[28:31], s16 offen offset:128 sc1
  s_add_u32 s18, s18, 133120
  ds_read_b64_tr_b16 v[208:209], v155 offset:20576
  ds_read_b64_tr_b16 v[210:211], v155 offset:21856
  s_waitcnt lgkmcnt(12)
  v_mfma_f32_16x16x32_bf16 v[80:83], v[216:219], v[48:51], v[80:83]
  v_mfma_f32_16x16x32_bf16 v[100:103], v[216:219], v[52:55], v[100:103]
  ds_read_b64_tr_b16 v[212:213], v155 offset:20608
  ds_read_b64_tr_b16 v[214:215], v155 offset:21888
  s_waitcnt lgkmcnt(12)
  v_mfma_f32_16x16x32_bf16 v[84:87], v[220:223], v[48:51], v[84:87]
  v_mfma_f32_16x16x32_bf16 v[104:107], v[220:223], v[52:55], v[104:107]
  ds_read_b64_tr_b16 v[216:217], v155 offset:25600
  ds_read_b64_tr_b16 v[218:219], v155 offset:26880
  s_waitcnt lgkmcnt(12)
  v_mfma_f32_16x16x32_bf16 v[88:91], v[224:227], v[48:51], v[88:91]
  v_mfma_f32_16x16x32_bf16 v[108:111], v[224:227], v[52:55], v[108:111]
  ds_read_b64_tr_b16 v[220:221], v155 offset:25632
  ds_read_b64_tr_b16 v[222:223], v155 offset:26912
  s_waitcnt vmcnt(14)
  s_waitcnt lgkmcnt(12)
  v_mfma_f32_16x16x32_bf16 v[72:75], v[228:231], v[56:59], v[72:75]
  v_mfma_f32_16x16x32_bf16 v[92:95], v[228:231], v[60:63], v[92:95]
  ds_read_b64_tr_b16 v[224:225], v155 offset:25664
  ds_read_b64_tr_b16 v[226:227], v155 offset:26944
  s_waitcnt lgkmcnt(12)
  v_mfma_f32_16x16x32_bf16 v[76:79], v[232:235], v[56:59], v[76:79]
  v_mfma_f32_16x16x32_bf16 v[96:99], v[232:235], v[60:63], v[96:99]
  s_add_u32 s16, s18, 16640
  buffer_load_dwordx2 v[32:33], v131, s[28:31], s18 offen offset:0 sc1
  buffer_load_dwordx2 v[34:35], v131, s[28:31], s16 offen offset:0 sc1
  buffer_load_dwordx2 v[36:37], v131, s[28:31], s18 offen offset:128 sc1
  buffer_load_dwordx2 v[38:39], v131, s[28:31], s16 offen offset:128 sc1
  s_add_u32 s18, s18, 133120
  ds_read_b64_tr_b16 v[228:229], v155 offset:25696
  ds_read_b64_tr_b16 v[230:231], v155 offset:26976
  s_waitcnt lgkmcnt(12)
  v_mfma_f32_16x16x32_bf16 v[80:83], v[204:207], v[56:59], v[80:83]
  v_mfma_f32_16x16x32_bf16 v[100:103], v[204:207], v[60:63], v[100:103]
  ds_read_b64_tr_b16 v[232:233], v155 offset:25728
  ds_read_b64_tr_b16 v[234:235], v155 offset:27008
  s_waitcnt lgkmcnt(12)
  v_mfma_f32_16x16x32_bf16 v[84:87], v[208:211], v[56:59], v[84:87]
  v_mfma_f32_16x16x32_bf16 v[104:107], v[208:211], v[60:63], v[104:107]
  ds_read_b64_tr_b16 v[204:205], v155 offset:30720
  ds_read_b64_tr_b16 v[206:207], v155 offset:32000
  s_waitcnt lgkmcnt(12)
  v_mfma_f32_16x16x32_bf16 v[88:91], v[212:215], v[56:59], v[88:91]
  v_mfma_f32_16x16x32_bf16 v[108:111], v[212:215], v[60:63], v[108:111]
  ds_read_b64_tr_b16 v[208:209], v155 offset:30752
  ds_read_b64_tr_b16 v[210:211], v155 offset:32032
  s_waitcnt vmcnt(16)
  s_waitcnt lgkmcnt(12)
  v_mfma_f32_16x16x32_bf16 v[72:75], v[216:219], v[64:67], v[72:75]
  v_mfma_f32_16x16x32_bf16 v[92:95], v[216:219], v[68:71], v[92:95]
  ds_read_b64_tr_b16 v[212:213], v155 offset:30784
  ds_read_b64_tr_b16 v[214:215], v155 offset:32064
  s_waitcnt lgkmcnt(12)
  v_mfma_f32_16x16x32_bf16 v[76:79], v[220:223], v[64:67], v[76:79]
  v_mfma_f32_16x16x32_bf16 v[96:99], v[220:223], v[68:71], v[96:99]
  ds_read_b64_tr_b16 v[216:217], v155 offset:30816
  ds_read_b64_tr_b16 v[218:219], v155 offset:32096
  s_waitcnt lgkmcnt(12)
  v_mfma_f32_16x16x32_bf16 v[80:83], v[224:227], v[64:67], v[80:83]
  v_mfma_f32_16x16x32_bf16 v[100:103], v[224:227], v[68:71], v[100:103]
  ds_read_b64_tr_b16 v[220:221], v155 offset:30848
  ds_read_b64_tr_b16 v[222:223], v155 offset:32128
  s_waitcnt lgkmcnt(12)
  v_mfma_f32_16x16x32_bf16 v[84:87], v[228:231], v[64:67], v[84:87]
  v_mfma_f32_16x16x32_bf16 v[104:107], v[228:231], v[68:71], v[104:107]
  ds_read_b64_tr_b16 v[224:225], v155 offset:35840
  ds_read_b64_tr_b16 v[226:227], v155 offset:37120
  s_waitcnt lgkmcnt(12)
  v_mfma_f32_16x16x32_bf16 v[88:91], v[232:235], v[64:67], v[88:91]
  v_mfma_f32_16x16x32_bf16 v[108:111], v[232:235], v[68:71], v[108:111]
  ds_read_b64_tr_b16 v[228:229], v155 offset:35872
  ds_read_b64_tr_b16 v[230:231], v155 offset:37152
  s_waitcnt vmcnt(12)
  s_waitcnt lgkmcnt(12)
  v_mfma_f32_16x16x32_bf16 v[72:75], v[204:207], v[8:11], v[72:75]
  v_mfma_f32_16x16x32_bf16 v[92:95], v[204:207], v[12:15], v[92:95]
  ds_read_b64_tr_b16 v[232:233], v155 offset:35904
  ds_read_b64_tr_b16 v[234:235], v155 offset:37184
  s_waitcnt lgkmcnt(12)
  v_mfma_f32_16x16x32_bf16 v[76:79], v[208:211], v[8:11], v[76:79]
  v_mfma_f32_16x16x32_bf16 v[96:99], v[208:211], v[12:15], v[96:99]
  ds_read_b64_tr_b16 v[204:205], v155 offset:35936
  ds_read_b64_tr_b16 v[206:207], v155 offset:37216
  s_waitcnt lgkmcnt(12)
  v_mfma_f32_16x16x32_bf16 v[80:83], v[212:215], v[8:11], v[80:83]
  v_mfma_f32_16x16x32_bf16 v[100:103], v[212:215], v[12:15], v[100:103]
  ds_read_b64_tr_b16 v[208:209], v155 offset:35968
  ds_read_b64_tr_b16 v[210:211], v155 offset:37248
  s_waitcnt lgkmcnt(12)
  v_mfma_f32_16x16x32_bf16 v[84:87], v[216:219], v[8:11], v[84:87]
  v_mfma_f32_16x16x32_bf16 v[104:107], v[216:219], v[12:15], v[104:107]
  ds_read_b64_tr_b16 v[212:213], v155 offset:40960
  ds_read_b64_tr_b16 v[214:215], v155 offset:42240
  s_waitcnt lgkmcnt(12)
  v_mfma_f32_16x16x32_bf16 v[88:91], v[220:223], v[8:11], v[88:91]
  v_mfma_f32_16x16x32_bf16 v[108:111], v[220:223], v[12:15], v[108:111]
  ds_read_b64_tr_b16 v[216:217], v155 offset:40992
  ds_read_b64_tr_b16 v[218:219], v155 offset:42272
  s_waitcnt vmcnt(8)
  s_waitcnt lgkmcnt(12)
  v_mfma_f32_16x16x32_bf16 v[72:75], v[224:227], v[16:19], v[72:75]
  v_mfma_f32_16x16x32_bf16 v[92:95], v[224:227], v[20:23], v[92:95]
  ds_read_b64_tr_b16 v[220:221], v155 offset:41024
  ds_read_b64_tr_b16 v[222:223], v155 offset:42304
  s_waitcnt lgkmcnt(12)
  v_mfma_f32_16x16x32_bf16 v[76:79], v[228:231], v[16:19], v[76:79]
  v_mfma_f32_16x16x32_bf16 v[96:99], v[228:231], v[20:23], v[96:99]
  ds_read_b64_tr_b16 v[224:225], v155 offset:41056
  ds_read_b64_tr_b16 v[226:227], v155 offset:42336
  s_waitcnt lgkmcnt(12)
  v_mfma_f32_16x16x32_bf16 v[80:83], v[232:235], v[16:19], v[80:83]
  v_mfma_f32_16x16x32_bf16 v[100:103], v[232:235], v[20:23], v[100:103]
  ds_read_b64_tr_b16 v[228:229], v155 offset:41088
  ds_read_b64_tr_b16 v[230:231], v155 offset:42368
  s_waitcnt lgkmcnt(12)
  v_mfma_f32_16x16x32_bf16 v[84:87], v[204:207], v[16:19], v[84:87]
  v_mfma_f32_16x16x32_bf16 v[104:107], v[204:207], v[20:23], v[104:107]
  ds_read_b64_tr_b16 v[232:233], v155 offset:46080
  ds_read_b64_tr_b16 v[234:235], v155 offset:47360
  s_waitcnt lgkmcnt(12)
  v_mfma_f32_16x16x32_bf16 v[88:91], v[208:211], v[16:19], v[88:91]
  v_mfma_f32_16x16x32_bf16 v[108:111], v[208:211], v[20:23], v[108:111]
  ds_read_b64_tr_b16 v[204:205], v155 offset:46112
  ds_read_b64_tr_b16 v[206:207], v155 offset:47392
  s_waitcnt vmcnt(4)
  s_waitcnt lgkmcnt(12)
  v_mfma_f32_16x16x32_bf16 v[72:75], v[212:215], v[24:27], v[72:75]
  v_mfma_f32_16x16x32_bf16 v[92:95], v[212:215], v[28:31], v[92:95]
  ds_read_b64_tr_b16 v[208:209], v155 offset:46144
  ds_read_b64_tr_b16 v[210:211], v155 offset:47424
  s_waitcnt lgkmcnt(12)
  v_mfma_f32_16x16x32_bf16 v[76:79], v[216:219], v[24:27], v[76:79]
  v_mfma_f32_16x16x32_bf16 v[96:99], v[216:219], v[28:31], v[96:99]
  ds_read_b64_tr_b16 v[212:213], v155 offset:46176
  ds_read_b64_tr_b16 v[214:215], v155 offset:47456
  s_waitcnt lgkmcnt(12)
  v_mfma_f32_16x16x32_bf16 v[80:83], v[220:223], v[24:27], v[80:83]
  v_mfma_f32_16x16x32_bf16 v[100:103], v[220:223], v[28:31], v[100:103]
  ds_read_b64_tr_b16 v[216:217], v155 offset:46208
  ds_read_b64_tr_b16 v[218:219], v155 offset:47488
  s_waitcnt lgkmcnt(12)
  v_mfma_f32_16x16x32_bf16 v[84:87], v[224:227], v[24:27], v[84:87]
  v_mfma_f32_16x16x32_bf16 v[104:107], v[224:227], v[28:31], v[104:107]
  s_waitcnt lgkmcnt(10)
  v_mfma_f32_16x16x32_bf16 v[88:91], v[228:231], v[24:27], v[88:91]
  v_mfma_f32_16x16x32_bf16 v[108:111], v[228:231], v[28:31], v[108:111]
  s_waitcnt vmcnt(0)
  s_waitcnt lgkmcnt(8)
  v_mfma_f32_16x16x32_bf16 v[72:75], v[232:235], v[32:35], v[72:75]
  v_mfma_f32_16x16x32_bf16 v[92:95], v[232:235], v[36:39], v[92:95]
  s_waitcnt lgkmcnt(6)
  v_mfma_f32_16x16x32_bf16 v[76:79], v[204:207], v[32:35], v[76:79]
  v_mfma_f32_16x16x32_bf16 v[96:99], v[204:207], v[36:39], v[96:99]
  s_waitcnt lgkmcnt(4)
  v_mfma_f32_16x16x32_bf16 v[80:83], v[208:211], v[32:35], v[80:83]
  v_mfma_f32_16x16x32_bf16 v[100:103], v[208:211], v[36:39], v[100:103]
  s_waitcnt lgkmcnt(2)
  v_mfma_f32_16x16x32_bf16 v[84:87], v[212:215], v[32:35], v[84:87]
  v_mfma_f32_16x16x32_bf16 v[104:107], v[212:215], v[36:39], v[104:107]
  s_waitcnt lgkmcnt(0)
  v_mfma_f32_16x16x32_bf16 v[88:91], v[216:219], v[32:35], v[88:91]
  v_mfma_f32_16x16x32_bf16 v[108:111], v[216:219], v[36:39], v[108:111]
  s_nop 7
  v_cvt_pk_bf16_f32 v204, v72, v73
  v_cvt_pk_bf16_f32 v205, v74, v75
  ds_write_b64 v138, v[204:205] offset:0
  v_cvt_pk_bf16_f32 v206, v76, v77
  v_cvt_pk_bf16_f32 v207, v78, v79
  ds_write_b64 v138, v[206:207] offset:32
  v_cvt_pk_bf16_f32 v208, v80, v81
  v_cvt_pk_bf16_f32 v209, v82, v83
  ds_write_b64 v138, v[208:209] offset:64
  v_cvt_pk_bf16_f32 v210, v84, v85
  v_cvt_pk_bf16_f32 v211, v86, v87
  ds_write_b64 v138, v[210:211] offset:96
  v_cvt_pk_bf16_f32 v212, v88, v89
  v_cvt_pk_bf16_f32 v213, v90, v91
  ds_write_b64 v138, v[212:213] offset:128
  v_cvt_pk_bf16_f32 v214, v92, v93
  v_cvt_pk_bf16_f32 v215, v94, v95
  ds_write_b64 v138, v[214:215] offset:2560
  v_cvt_pk_bf16_f32 v216, v96, v97
  v_cvt_pk_bf16_f32 v217, v98, v99
  ds_write_b64 v138, v[216:217] offset:2592
  v_cvt_pk_bf16_f32 v218, v100, v101
  v_cvt_pk_bf16_f32 v219, v102, v103
  ds_write_b64 v138, v[218:219] offset:2624
  v_cvt_pk_bf16_f32 v204, v104, v105
  v_cvt_pk_bf16_f32 v205, v106, v107
  ds_write_b64 v138, v[204:205] offset:2656
  v_cvt_pk_bf16_f32 v206, v108, v109
  v_cvt_pk_bf16_f32 v207, v110, v111
  ds_write_b64 v138, v[206:207] offset:2688
  s_mul_i32 s14, s63, 2560
  s_mul_i32 s15, s61, 1280
  s_add_u32 s14, s14, s15
  s_mul_i32 s15, s62, 160
  s_add_u32 s14, s14, s15
  s_waitcnt lgkmcnt(0)
  ds_read_b128 v[8:11], v158 offset:0
  ds_read_b128 v[12:15], v158 offset:1024
  ds_read_b128 v[16:19], v158 offset:2048
  ds_read_b128 v[20:23], v158 offset:3072
  ds_read_b128 v[24:27], v158 offset:4096
  s_waitcnt lgkmcnt(4)
  buffer_store_dwordx4 v[8:11], v132, s[92:95], s14 offen
  s_waitcnt lgkmcnt(3)
  buffer_store_dwordx4 v[12:15], v133, s[92:95], s14 offen
  s_waitcnt lgkmcnt(2)
  buffer_store_dwordx4 v[16:19], v134, s[92:95], s14 offen
  s_waitcnt lgkmcnt(1)
  buffer_store_dwordx4 v[20:23], v135, s[92:95], s14 offen
  s_waitcnt lgkmcnt(0)
  buffer_store_dwordx4 v[24:27], v136, s[92:95], s14 offen
k2_kernel_p3done:
  s_endpgm
k2_kernel_prio1:
  s_setprio 0
  s_branch k2_kernel_prio1r
k2_kernel_prio2:
  s_setprio 0
  s_branch k2_kernel_prio2r
k2_kernel_dma0:
  s_add_u32 m0, s50, 0
  s_add_u32 s14, m0, s25
  buffer_load_dwordx4 v199, s[28:31], s14 offen  lds
  s_cmp_eq_u32 s26, 0
  s_branch k2_kernel_dma0r
k2_kernel_dma1:
  s_add_u32 m0, s50, 32768
  s_add_u32 s14, m0, s25
  buffer_load_dwordx4 v199, s[28:31], s14 offen  lds
  s_cmp_eq_u32 s26, 0
  s_branch k2_kernel_dma1r
k2_kernel_dma2:
  s_add_u32 m0, s51, 0
  s_add_u32 s14, m0, s25
  buffer_load_dwordx4 v199, s[28:31], s14 offen  lds
  s_cmp_eq_u32 s26, 0
  s_branch k2_kernel_dma2r
k2_kernel_dma3:
  s_add_u32 m0, s51, 1024
  s_add_u32 s14, m0, s25
  buffer_load_dwordx4 v199, s[28:31], s14 offen  lds
  s_cmp_eq_u32 s26, 0
  s_branch k2_kernel_dma3r
k2_kernel_dma4:
  s_add_u32 m0, s52, 0
  s_add_u32 s14, m0, s25
  buffer_load_dwordx4 v199, s[28:31], s14 offen  lds
  s_cmp_eq_u32 s26, 0
  s_branch k2_kernel_dma4r
k2_kernel_dma5:
  s_add_u32 m0, s50, 0
  s_add_u32 m0, m0, 4096
  s_add_u32 s14, m0, s25
  buffer_load_dwordx4 v199, s[28:31], s14 offen  lds
  s_cmp_eq_u32 s26, 0
  s_branch k2_kernel_dma5r
k2_kernel_dma6:
  s_add_u32 m0, s50, 32768
  s_add_u32 m0, m0, 4096
  s_add_u32 s14, m0, s25
  buffer_load_dwordx4 v199, s[28:31], s14 offen  lds
  s_cmp_eq_u32 s26, 0
  s_branch k2_kernel_dma6r
k2_kernel_dma7:
  s_add_u32 m0, s51, 0
  s_add_u32 m0, m0, 10240
  s_add_u32 s14, m0, s25
  buffer_load_dwordx4 v199, s[28:31], s14 offen  lds
  s_cmp_eq_u32 s26, 1
  s_branch k2_kernel_dma7r
k2_kernel_dma8:
  s_add_u32 m0, s51, 1024
  s_add_u32 m0, m0, 10240
  s_add_u32 s14, m0, s25
  buffer_load_dwordx4 v199, s[28:31], s14 offen  lds
  s_cmp_eq_u32 s26, 1
  s_branch k2_kernel_dma8r
k2_kernel_dma9:
  s_add_u32 m0, s52, 0
  s_add_u32 m0, m0, s53
  s_add_u32 s14, m0, s25
  buffer_load_dwordx4 v199, s[28:31], s14 offen  lds
  s_cmp_eq_u32 s26, 1
  s_branch k2_kernel_dma9r
k2_kernel_hook:
  s_cmp_ge_u32 s26, 2
  s_cbranch_scc1 k2_kernel_hook23
  s_waitcnt vmcnt(0)
  s_barrier
  s_cmp_eq_u32 s27, 0
  s_cbranch_scc1 k2_kernel_hk1
  s_setprio 2
k2_kernel_hk1:
  s_cmp_eq_u32 s26, 1
  s_cbranch_scc1 k2_kernel_hook1
  s_cmp_lg_u32 s20, 0
  s_cbranch_scc1 k2_kernel_hookret
  s_add_u32 s14, s34, 1
  v_mov_b32 v2, s14
  v_mov_b32 v3, 0
  s_lshl_b32 s14, s21, 3
  s_add_u32 s14, s14, s22
  s_lshl_b32 s14, s14, 7
  s_add_u32 s14, s14, 22806528
  s_mov_b64 exec, 1
  buffer_store_dword v2, v3, s[28:31], s14 offen sc1
  s_mov_b64 exec, -1
  s_branch k2_kernel_hookret
k2_kernel_hook1:
  v_and_b32 v3, 7, v1
  v_lshlrev_b32 v3, 7, v3
  s_lshl_b32 s14, s21, 10
  s_add_u32 s14, s14, 22806528
  buffer_load_dword v198, v3, s[28:31], s14 offen sc1
  s_lshr_b32 s14, s2, 3
  s_mul_i32 s14, s14, 25600
  s_mul_i32 s15, s20, 3200
  s_add_u32 s14, s14, s15
  buffer_load_dwordx4 v[182:185], v199, s[36:39], s14 offen offset:0
  buffer_load_dwordx4 v[186:189], v199, s[36:39], s14 offen offset:1024
  buffer_load_dwordx4 v[190:193], v199, s[36:39], s14 offen offset:2048
  buffer_load_dwordx4 v[194:197], v199, s[36:39], s14 offen offset:3072
  s_branch k2_kernel_hookret
k2_kernel_hook23:
  s_waitcnt vmcnt(0)
  v_cmp_eq_u32 vcc, v198, v242
  s_nop 1
  s_cmp_eq_u64 vcc, 0
  s_cbranch_scc1 k2_kernel_hook_got
  v_and_b32 v3, 7, v1
  v_lshlrev_b32 v3, 7, v3
  s_lshl_b32 s14, s21, 10
  s_add_u32 s14, s14, 22806528
  buffer_load_dword v198, v3, s[28:31], s14 offen sc1
  s_branch k2_kernel_hookret
k2_kernel_hook_got:
  s_mov_b32 s54, 1
  s_mov_b32 s60, 0
  s_lshl_b32 s14, s21, 3
  s_mul_i32 s14, s14, 3360
  s_add_u32 s14, s14, 23068672
  s_add_u32 s15, s14, 0
  buffer_load_dword v182, v240, s[28:31], s15 offen sc1
  s_add_u32 s15, s14, 3360
  buffer_load_dword v183, v240, s[28:31], s15 offen sc1
  s_add_u32 s15, s14, 6720
  buffer_load_dword v184, v240, s[28:31], s15 offen sc1
  s_add_u32 s15, s14, 10080
  buffer_load_dword v185, v240, s[28:31], s15 offen sc1
  s_add_u32 s15, s14, 13440
  buffer_load_dword v186, v240, s[28:31], s15 offen sc1
  s_add_u32 s15, s14, 16800
  buffer_load_dword v187, v240, s[28:31], s15 offen sc1
  s_add_u32 s15, s14, 20160
  buffer_load_dword v188, v240, s[28:31], s15 offen sc1
  s_add_u32 s15, s14, 23520
  buffer_load_dword v189, v240, s[28:31], s15 offen sc1
  s_add_u32 s15, s14, 0
  buffer_load_dword v190, v241, s[28:31], s15 offen sc1
  s_add_u32 s15, s14, 3360
  buffer_load_dword v191, v241, s[28:31], s15 offen sc1
  s_add_u32 s15, s14, 6720
  buffer_load_dword v192, v241, s[28:31], s15 offen sc1
  s_add_u32 s15, s14, 10080
  buffer_load_dword v193, v241, s[28:31], s15 offen sc1
  s_add_u32 s15, s14, 13440
  buffer_load_dword v194, v241, s[28:31], s15 offen sc1
  s_add_u32 s15, s14, 16800
  buffer_load_dword v195, v241, s[28:31], s15 offen sc1
  s_add_u32 s15, s14, 20160
  buffer_load_dword v196, v241, s[28:31], s15 offen sc1
  s_add_u32 s15, s14, 23520
  buffer_load_dword v197, v241, s[28:31], s15 offen sc1
  s_branch k2_kernel_hookret
k2_kernel_slowpoll:
  s_mov_b32 s26, 0
k2_kernel_sp1:
  v_and_b32 v3, 7, v1
  v_lshlrev_b32 v3, 7, v3
  s_lshl_b32 s14, s21, 10
  s_add_u32 s14, s14, 22806528
  buffer_load_dword v198, v3, s[28:31], s14 offen sc1
  s_waitcnt vmcnt(0)
  v_cmp_eq_u32 vcc, v198, v242
  s_nop 1
  s_cmp_eq_u64 vcc, 0
  s_cbranch_scc1 k2_kernel_sp2
  s_sleep 8
  s_add_u32 s26, s26, 1
  s_cmp_lt_u32 s26, 400
  s_cbranch_scc1 k2_kernel_sp1
  s_mov_b32 s54, 2
  s_branch k2_kernel_ok2
k2_kernel_sp2:
  s_mov_b32 s54, 1
  s_lshl_b32 s14, s21, 3
  s_mul_i32 s14, s14, 3360
  s_add_u32 s14, s14, 23068672
  s_add_u32 s15, s14, 0
  buffer_load_dword v182, v240, s[28:31], s15 offen sc1
  s_add_u32 s15, s14, 3360
  buffer_load_dword v183, v240, s[28:31], s15 offen sc1
  s_add_u32 s15, s14, 6720
  buffer_load_dword v184, v240, s[28:31], s15 offen sc1
  s_add_u32 s15, s14, 10080
  buffer_load_dword v185, v240, s[28:31], s15 offen sc1
  s_add_u32 s15, s14, 13440
  buffer_load_dword v186, v240, s[28:31], s15 offen sc1
  s_add_u32 s15, s14, 16800
  buffer_load_dword v187, v240, s[28:31], s15 offen sc1
  s_add_u32 s15, s14, 20160
  buffer_load_dword v188, v240, s[28:31], s15 offen sc1
  s_add_u32 s15, s14, 23520
  buffer_load_dword v189, v240, s[28:31], s15 offen sc1
  s_add_u32 s15, s14, 0
  buffer_load_dword v190, v241, s[28:31], s15 offen sc1
  s_add_u32 s15, s14, 3360
  buffer_load_dword v191, v241, s[28:31], s15 offen sc1
  s_add_u32 s15, s14, 6720
  buffer_load_dword v192, v241, s[28:31], s15 offen sc1
  s_add_u32 s15, s14, 10080
  buffer_load_dword v193, v241, s[28:31], s15 offen sc1
  s_add_u32 s15, s14, 13440
  buffer_load_dword v194, v241, s[28:31], s15 offen sc1
  s_add_u32 s15, s14, 16800
  buffer_load_dword v195, v241, s[28:31], s15 offen sc1
  s_add_u32 s15, s14, 20160
  buffer_load_dword v196, v241, s[28:31], s15 offen sc1
  s_add_u32 s15, s14, 23520
  buffer_load_dword v197, v241, s[28:31], s15 offen sc1
  s_branch k2_kernel_ok2
k2_kernel_recompute:
  s_waitcnt vmcnt(0)
  s_barrier
  s_mul_i32 s14, s21, 3072
  s_add_u32 s14, s14, 22544384
  buffer_load_dwordx4 v[8:11], v199, s[28:31], s14 offen offset:0
  buffer_load_dwordx4 v[12:15], v199, s[28:31], s14 offen offset:1024
  buffer_load_dwordx4 v[16:19], v199, s[28:31], s14 offen offset:2048
  s_mov_b32 s14, 22942720
  buffer_load_dwordx4 v[190:193], v199, s[28:31], s14 offen
  v_lshlrev_b32 v5, 4, v0
  s_mov_b32 s14, 22945792
  buffer_load_dwordx4 v[194:197], v5, s[28:31], s14 offen
  s_mov_b32 s14, 22953984
  buffer_load_dwordx4 v[236:239], v5, s[28:31], s14 offen
  s_waitcnt vmcnt(0)
  v_add_u32 v190, s55, v190
  v_add_u32 v191, s55, v191
  v_add_u32 v192, s56, v192
  v_add_u32 v193, s56, v193
  v_mov_b32 v240, v196
  v_mov_b32 v241, v197
  v_mov_b32 v204, 0
  v_mov_b32 v205, 0
  v_mov_b32 v206, 0
  v_mov_b32 v207, 0
  v_mov_b32 v208, 0
  v_mov_b32 v209, 0
  v_mov_b32 v210, 0
  v_mov_b32 v211, 0
  v_mov_b32 v212, 0
  v_mov_b32 v213, 0
  v_mov_b32 v214, 0
  v_mov_b32 v215, 0
  v_mov_b32 v216, 0
  v_mov_b32 v217, 0
  v_mov_b32 v218, 0
  v_mov_b32 v219, 0
  v_mov_b32 v220, 0
  v_mov_b32 v221, 0
  v_mov_b32 v222, 0
  v_mov_b32 v223, 0
  v_mov_b32 v224, 0
  v_mov_b32 v225, 0
  v_mov_b32 v226, 0
  v_mov_b32 v227, 0
  v_mov_b32 v228, 0
  v_mov_b32 v229, 0
  v_mov_b32 v230, 0
  v_mov_b32 v231, 0
  v_mov_b32 v232, 0
  v_mov_b32 v233, 0
  v_mov_b32 v234, 0
  v_mov_b32 v235, 0
  s_mov_b32 s57, 0
k2_kernel_rc1:
  v_lshlrev_b32 v2, 15, v7
  v_lshl_add_u32 v2, v6, 4, v2
  v_lshlrev_b32 v3, 3, v6
  v_mul_u32_u24 v4, 320, v7
  v_lshl_add_u32 v4, v6, 4, v4
  s_lshl_b32 s43, s57, 8
  s_lshl_b32 s14, s20, 5
  s_add_u32 s43, s43, s14
  s_lshl_b32 s14, s43, 4
  s_add_u32 s14, s14, s47
  buffer_load_dwordx4 v[24:27], v2, s[28:31], s14 offen
  s_lshl_b32 s14, s43, 3
  s_add_u32 s14, s14, s47
  s_add_u32 s14, s14, 65536
  buffer_load_dwordx2 v[28:29], v3, s[28:31], s14 offen
  s_lshr_b32 s14, s43, 5
  s_mul_i32 s14, s14, 1280
  s_add_u32 s14, s14, s47
  s_add_u32 s14, s14, 81920
  buffer_load_dwordx4 v[182:185], v4, s[28:31], s14 offen
  buffer_load_dwordx4 v[186:189], v4, s[28:31], s14 offen offset:640
  s_waitcnt vmcnt(0)
  v_cmp_eq_u32 vcc, 20, v6
  v_mov_b32 v5, 0x3f803f80
  s_nop 0
  v_cndmask_b32 v182, v182, v5, vcc
  v_cndmask_b32 v183, v183, v5, vcc
  v_cndmask_b32 v184, v184, v5, vcc
  v_cndmask_b32 v185, v185, v5, vcc
  v_cndmask_b32 v186, v186, v5, vcc
  v_cndmask_b32 v187, v187, v5, vcc
  v_cndmask_b32 v188, v188, v5, vcc
  v_cndmask_b32 v189, v189, v5, vcc
  v_mfma_f32_32x32x16_bf16 v[40:55], v[8:11], v[24:27], 0
  v_mfma_f32_32x32x16_bf16 v[56:71], v[12:15], v[24:27], 0
  v_mfma_f32_32x32x8bf16_1k v[40:55], v[16:17], v[28:29], v[40:55]
  v_mfma_f32_32x32x8bf16_1k v[56:71], v[18:19], v[28:29], v[56:71]
  s_nop 7
  s_nop 3
  v_max3_f32 v36, v40, v41, v42
  v_max3_f32 v36, v43, v44, v36
  v_max3_f32 v36, v45, v46, v36
  v_max3_f32 v36, v47, v48, v36
  v_max3_f32 v36, v49, v50, v36
  v_max3_f32 v36, v51, v52, v36
  v_max3_f32 v36, v53, v54, v36
  v_max3_f32 v36, v55, v56, v36
  v_max3_f32 v36, v57, v58, v36
  v_max_f32 v36, v59, v36
  v_mul_f32 v36, 0xbfb8aa3b, v36
  s_mov_b32 s14, 0x3fb8aa3b
  s_mov_b32 s15, 0x3fb8aa3b
  v_mov_b32 v37, v36
  v_pk_fma_f32 v[40:41], v[40:41], s[14:15], v[36:37]
  v_pk_fma_f32 v[42:43], v[42:43], s[14:15], v[36:37]
  v_pk_fma_f32 v[44:45], v[44:45], s[14:15], v[36:37]
  v_pk_fma_f32 v[46:47], v[46:47], s[14:15], v[36:37]
  v_pk_fma_f32 v[48:49], v[48:49], s[14:15], v[36:37]
  v_pk_fma_f32 v[50:51], v[50:51], s[14:15], v[36:37]
  v_pk_fma_f32 v[52:53], v[52:53], s[14:15], v[36:37]
  v_pk_fma_f32 v[54:55], v[54:55], s[14:15], v[36:37]
  v_pk_fma_f32 v[56:57], v[56:57], s[14:15], v[36:37]
  v_pk_fma_f32 v[58:59], v[58:59], s[14:15], v[36:37]
  v_exp_f32 v40, v40
  v_exp_f32 v41, v41
  v_exp_f32 v42, v42
  v_exp_f32 v43, v43
  v_exp_f32 v44, v44
  v_exp_f32 v45, v45
  v_exp_f32 v46, v46
  v_exp_f32 v47, v47
  v_exp_f32 v48, v48
  v_exp_f32 v49, v49
  v_exp_f32 v50, v50
  v_exp_f32 v51, v51
  v_exp_f32 v52, v52
  v_exp_f32 v53, v53
  v_exp_f32 v54, v54
  v_exp_f32 v55, v55
  v_exp_f32 v56, v56
  v_exp_f32 v57, v57
  v_exp_f32 v58, v58
  v_exp_f32 v59, v59
  s_nop 0
  v_pk_add_f32 v[38:39], v[40:41], v[42:43]
  v_pk_add_f32 v[38:39], v[38:39], v[44:45]
  v_pk_add_f32 v[38:39], v[38:39], v[46:47]
  v_pk_add_f32 v[38:39], v[38:39], v[48:49]
  v_pk_add_f32 v[38:39], v[38:39], v[50:51]
  v_pk_add_f32 v[38:39], v[38:39], v[52:53]
  v_pk_add_f32 v[38:39], v[38:39], v[54:55]
  v_pk_add_f32 v[38:39], v[38:39], v[56:57]
  v_pk_add_f32 v[38:39], v[38:39], v[58:59]
  v_add_f32 v38, v38, v39
  v_rcp_f32 v38, v38
  s_nop 0
  v_mov_b32 v39, v38
  v_pk_mul_f32 v[40:41], v[40:41], v[38:39]
  v_pk_mul_f32 v[42:43], v[42:43], v[38:39]
  v_pk_mul_f32 v[44:45], v[44:45], v[38:39]
  v_pk_mul_f32 v[46:47], v[46:47], v[38:39]
  v_pk_mul_f32 v[48:49], v[48:49], v[38:39]
  v_pk_mul_f32 v[50:51], v[50:51], v[38:39]
  v_pk_mul_f32 v[52:53], v[52:53], v[38:39]
  v_pk_mul_f32 v[54:55], v[54:55], v[38:39]
  v_pk_mul_f32 v[56:57], v[56:57], v[38:39]
  v_pk_mul_f32 v[58:59], v[58:59], v[38:39]
  v_cvt_pk_bf16_f32 v120, v40, v41
  v_cvt_pk_bf16_f32 v121, v42, v43
  v_cvt_pk_bf16_f32 v122, v44, v45
  v_cvt_pk_bf16_f32 v123, v46, v47
  v_cvt_pk_bf16_f32 v124, v48, v49
  v_cvt_pk_bf16_f32 v125, v50, v51
  v_cvt_pk_bf16_f32 v126, v52, v53
  v_cvt_pk_bf16_f32 v127, v54, v55
  v_cvt_pk_bf16_f32 v128, v56, v57
  v_cvt_pk_bf16_f32 v129, v58, v59
  v_mov_b32 v130, 0
  v_mov_b32 v131, 0
  ds_write_b64 v190, v[120:121] offset:0
  ds_write_b64 v190, v[122:123] offset:8
  ds_write_b64 v190, v[124:125] offset:16
  ds_write_b64 v190, v[126:127] offset:24
  ds_write_b64 v190, v[128:129] offset:32
  s_waitcnt lgkmcnt(0)
  ds_read_b64_tr_b16 v[154:155], v191 offset:0
  ds_read_b64_tr_b16 v[156:157], v191 offset:320
  ds_read_b64_tr_b16 v[158:159], v191 offset:64
  ds_read_b64_tr_b16 v[160:161], v191 offset:384
  ds_read_b64_tr_b16 v[162:163], v191 offset:1280
  ds_read_b64_tr_b16 v[164:165], v191 offset:1600
  ds_read_b64_tr_b16 v[166:167], v191 offset:1344
  ds_read_b64_tr_b16 v[168:169], v191 offset:1664
  s_waitcnt lgkmcnt(6)
  v_mfma_f32_32x32x16_bf16 v[204:219], v[182:185], v[154:157], v[204:219]
  s_waitcnt lgkmcnt(4)
  v_mfma_f32_32x32x16_bf16 v[220:235], v[182:185], v[158:161], v[220:235]
  s_waitcnt lgkmcnt(2)
  v_mfma_f32_32x32x16_bf16 v[204:219], v[186:189], v[162:165], v[204:219]
  s_waitcnt lgkmcnt(0)
  v_mfma_f32_32x32x16_bf16 v[220:235], v[186:189], v[166:169], v[220:235]
  s_nop 7
  s_nop 7
  s_add_u32 s57, s57, 1
  s_cmp_lt_u32 s57, 8
  s_cbranch_scc1 k2_kernel_rc1
  ds_write_b32 v192, v204 offset:0
  ds_write_b32 v192, v205 offset:128
  ds_write_b32 v192, v206 offset:256
  ds_write_b32 v192, v207 offset:384
  ds_write_b32 v192, v208 offset:1024
  ds_write_b32 v192, v209 offset:1152
  ds_write_b32 v192, v210 offset:1280
  ds_write_b32 v192, v211 offset:1408
  ds_write_b32 v192, v212 offset:2048
  ds_write_b32 v192, v213 offset:2176
  ds_write_b32 v192, v214 offset:2304
  ds_write_b32 v192, v215 offset:2432
  s_mov_b32 exec_lo, 0xff
  s_mov_b32 exec_hi, 0xff
  ds_write_b32 v193, v220 offset:3072
  ds_write_b32 v193, v221 offset:3104
  ds_write_b32 v193, v222 offset:3136
  ds_write_b32 v193, v223 offset:3168
  ds_write_b32 v193, v224 offset:3328
  ds_write_b32 v193, v225 offset:3360
  ds_write_b32 v193, v226 offset:3392
  ds_write_b32 v193, v227 offset:3424
  ds_write_b32 v193, v228 offset:3584
  ds_write_b32 v193, v229 offset:3616
  ds_write_b32 v193, v230 offset:3648
  ds_write_b32 v193, v231 offset:3680
  s_mov_b64 exec, -1
  s_waitcnt lgkmcnt(0)
  s_barrier
  ds_read_b32 v154, v194 offset:0
  ds_read_b32 v155, v194 offset:3840
  ds_read_b32 v156, v194 offset:7680
  ds_read_b32 v157, v194 offset:11520
  ds_read_b32 v158, v194 offset:40960
  ds_read_b32 v159, v194 offset:44800
  ds_read_b32 v160, v194 offset:48640
  ds_read_b32 v161, v194 offset:52480
  ds_read_b32 v162, v195 offset:0
  ds_read_b32 v163, v195 offset:3840
  ds_read_b32 v164, v195 offset:7680
  ds_read_b32 v165, v195 offset:11520
  ds_read_b32 v166, v195 offset:40960
  ds_read_b32 v167, v195 offset:44800
  ds_read_b32 v168, v195 offset:48640
  ds_read_b32 v169, v195 offset:52480
  s_waitcnt lgkmcnt(0)
  v_add_f32 v154, v154, v155
  v_add_f32 v162, v162, v163
  v_add_f32 v154, v154, v156
  v_add_f32 v162, v162, v164
  v_add_f32 v154, v154, v157
  v_add_f32 v162, v162, v165
  v_add_f32 v154, v154, v158
  v_add_f32 v162, v162, v166
  v_add_f32 v154, v154, v159
  v_add_f32 v162, v162, v167
  v_add_f32 v154, v154, v160
  v_add_f32 v162, v162, v168
  v_add_f32 v154, v154, v161
  v_add_f32 v162, v162, v169
  v_mov_b32 v182, v154
  v_cmp_gt_u32 vcc, 0x40000000, v241
  s_nop 1
  v_cndmask_b32 v190, 0, v162, vcc
  v_cvt_pk_bf16_f32 v182, v182, v182
  v_cvt_pk_bf16_f32 v190, v190, v190
  ds_write_b16 v236, v182 offset:32768
  ds_write_b16 v237, v190 offset:32768
  s_mov_b32 s14, 22937600
  buffer_load_dwordx4 v[120:123], v199, s[28:31], s14 offen offset:0
  buffer_load_dwordx4 v[124:127], v199, s[28:31], s14 offen offset:1024
  buffer_load_dwordx4 v[128:131], v199, s[28:31], s14 offen offset:2048
  buffer_load_dwordx4 v[132:135], v199, s[28:31], s14 offen offset:3072
  s_mov_b32 s14, 22941696
  buffer_load_dwordx4 v[136:139], v199, s[28:31], s14 offen
  s_waitcnt vmcnt(0) lgkmcnt(0)
  s_barrier
  ds_read_b128 v[8:11], v238 offset:32768
  ds_read_b128 v[12:15], v238 offset:32784
  ds_read_b128 v[16:19], v238 offset:32800
  s_waitcnt lgkmcnt(0)
  s_branch k2_kernel_bmfma
k2_kernel_fb:
  v_subrev_u32 v149, 16384, v149
  v_subrev_u32 v150, 8192, v150
  v_subrev_u32 v151, 40960, v151
  v_mov_b32 v152, 0xff800000
  v_mov_b32 v153, 0xff800000
  v_mov_b32 v158, v149
  v_mov_b32 v159, v150
  s_mov_b32 s26, 0
k2_kernel_fb1:
  ds_read_b128 v[120:123], v158
  ds_read_b128 v[124:127], v158 offset:512
  ds_read_b64 v[128:129], v159
  s_waitcnt lgkmcnt(0)
  v_mfma_f32_32x32x16_bf16 v[8:23], v[120:123], v[104:107], 0
  v_mfma_f32_32x32x8bf16_1k v[8:23], v[128:129], v[112:113], v[8:23]
  v_mfma_f32_32x32x16_bf16 v[24:39], v[120:123], v[108:111], 0
  v_mfma_f32_32x32x8bf16_1k v[24:39], v[128:129], v[114:115], v[24:39]
  v_mfma_f32_32x32x16_bf16 v[40:55], v[124:127], v[104:107], 0
  v_mfma_f32_32x32x8bf16_1k v[40:55], v[128:129], v[116:117], v[40:55]
  v_mfma_f32_32x32x16_bf16 v[56:71], v[124:127], v[108:111], 0
  v_mfma_f32_32x32x8bf16_1k v[56:71], v[128:129], v[118:119], v[56:71]
  s_nop 7
  s_nop 7
  v_max3_f32 v152, v8, v9, v152
  v_max3_f32 v152, v10, v11, v152
  v_max3_f32 v152, v12, v13, v152
  v_max3_f32 v152, v14, v15, v152
  v_max3_f32 v152, v16, v17, v152
  v_max3_f32 v152, v18, v19, v152
  v_max3_f32 v152, v20, v21, v152
  v_max3_f32 v152, v22, v23, v152
  v_max3_f32 v153, v24, v25, v153
  v_max3_f32 v153, v26, v27, v153
  v_max3_f32 v153, v28, v29, v153
  v_max3_f32 v153, v30, v31, v153
  v_max3_f32 v153, v32, v33, v153
  v_max3_f32 v153, v34, v35, v153
  v_max3_f32 v153, v36, v37, v153
  v_max3_f32 v153, v38, v39, v153
  v_max3_f32 v152, v40, v41, v152
  v_max3_f32 v152, v42, v43, v152
  v_max3_f32 v152, v44, v45, v152
  v_max3_f32 v152, v46, v47, v152
  v_max3_f32 v152, v48, v49, v152
  v_max3_f32 v152, v50, v51, v152
  v_max3_f32 v152, v52, v53, v152
  v_max3_f32 v152, v54, v55, v152
  v_max3_f32 v153, v56, v57, v153
  v_max3_f32 v153, v58, v59, v153
  v_max3_f32 v153, v60, v61, v153
  v_max3_f32 v153, v62, v63, v153
  v_max3_f32 v153, v64, v65, v153
  v_max3_f32 v153, v66, v67, v153
  v_max3_f32 v153, v68, v69, v153
  v_max3_f32 v153, v70, v71, v153
  v_add_u32 v158, 1024, v158
  v_add_u32 v159, 512, v159
  s_add_u32 s26, s26, 1
  s_cmp_lt_u32 s26, 16
  s_cbranch_scc1 k2_kernel_fb1
  v_mov_b32 v154, v152
  v_mov_b32 v155, v152
  s_nop 1
  v_permlane32_swap_b32 v154, v155
  s_nop 1
  v_max_f32 v152, v154, v155
  v_mov_b32 v154, v153
  v_mov_b32 v155, v153
  s_nop 1
  v_permlane32_swap_b32 v154, v155
  s_nop 1
  v_max_f32 v153, v154, v155
  v_mov_b32 v72, 0
  v_mov_b32 v73, 0
  v_mov_b32 v74, 0
  v_mov_b32 v75, 0
  v_mov_b32 v76, 0
  v_mov_b32 v77, 0
  v_mov_b32 v78, 0
  v_mov_b32 v79, 0
  v_mov_b32 v80, 0
  v_mov_b32 v81, 0
  v_mov_b32 v82, 0
  v_mov_b32 v83, 0
  v_mov_b32 v84, 0
  v_mov_b32 v85, 0
  v_mov_b32 v86, 0
  v_mov_b32 v87, 0
  v_mov_b32 v88, 0
  v_mov_b32 v89, 0
  v_mov_b32 v90, 0
  v_mov_b32 v91, 0
  v_mov_b32 v92, 0
  v_mov_b32 v93, 0
  v_mov_b32 v94, 0
  v_mov_b32 v95, 0
  v_mov_b32 v96, 0
  v_mov_b32 v97, 0
  v_mov_b32 v98, 0
  v_mov_b32 v99, 0
  v_mov_b32 v100, 0
  v_mov_b32 v101, 0
  v_mov_b32 v102, 0
  v_mov_b32 v103, 0
  v_mov_b32 v158, v149
  v_mov_b32 v159, v150
  v_mov_b32 v160, v151
  s_mov_b32 s26, 0
k2_kernel_fb2:
  s_mov_b64 exec, s[40:41]
  ds_read_b128 v[132:135], v160 offset:0
  ds_read_b128 v[140:143], v160 offset:640
  ds_read_b128 v[136:139], v160 offset:1280
  ds_read_b128 v[144:147], v160 offset:1920
  s_mov_b64 exec, -1
  ds_read_b128 v[120:123], v158
  ds_read_b128 v[124:127], v158 offset:512
  ds_read_b64 v[128:129], v159
  s_waitcnt lgkmcnt(0)
  v_mfma_f32_32x32x16_bf16 v[8:23], v[120:123], v[104:107], 0
  v_mfma_f32_32x32x8bf16_1k v[8:23], v[128:129], v[112:113], v[8:23]
  v_mfma_f32_32x32x16_bf16 v[24:39], v[120:123], v[108:111], 0
  v_mfma_f32_32x32x8bf16_1k v[24:39], v[128:129], v[114:115], v[24:39]
  v_mfma_f32_32x32x16_bf16 v[40:55], v[124:127], v[104:107], 0
  v_mfma_f32_32x32x8bf16_1k v[40:55], v[128:129], v[116:117], v[40:55]
  v_mfma_f32_32x32x16_bf16 v[56:71], v[124:127], v[108:111], 0
  v_mfma_f32_32x32x8bf16_1k v[56:71], v[128:129], v[118:119], v[56:71]
  s_nop 7
  s_nop 7
  v_sub_f32 v8, v8, v152
  v_sub_f32 v9, v9, v152
  v_sub_f32 v10, v10, v152
  v_sub_f32 v11, v11, v152
  v_sub_f32 v12, v12, v152
  v_sub_f32 v13, v13, v152
  v_sub_f32 v14, v14, v152
  v_sub_f32 v15, v15, v152
  v_sub_f32 v16, v16, v152
  v_sub_f32 v17, v17, v152
  v_sub_f32 v18, v18, v152
  v_sub_f32 v19, v19, v152
  v_sub_f32 v20, v20, v152
  v_sub_f32 v21, v21, v152
  v_sub_f32 v22, v22, v152
  v_sub_f32 v23, v23, v152
  v_exp_f32 v8, v8
  v_exp_f32 v9, v9
  v_exp_f32 v10, v10
  v_exp_f32 v11, v11
  v_exp_f32 v12, v12
  v_exp_f32 v13, v13
  v_exp_f32 v14, v14
  v_exp_f32 v15, v15
  v_exp_f32 v16, v16
  v_exp_f32 v17, v17
  v_exp_f32 v18, v18
  v_exp_f32 v19, v19
  v_exp_f32 v20, v20
  v_exp_f32 v21, v21
  v_exp_f32 v22, v22
  v_exp_f32 v23, v23
  s_nop 1
  v_smfmac_f32_32x32x32_bf16 v[72:87], v[132:135], v[8:15], v148
  v_smfmac_f32_32x32x32_bf16 v[72:87], v[140:143], v[16:23], v148
  v_sub_f32 v24, v24, v153
  v_sub_f32 v25, v25, v153
  v_sub_f32 v26, v26, v153
  v_sub_f32 v27, v27, v153
  v_sub_f32 v28, v28, v153
  v_sub_f32 v29, v29, v153
  v_sub_f32 v30, v30, v153
  v_sub_f32 v31, v31, v153
  v_sub_f32 v32, v32, v153
  v_sub_f32 v33, v33, v153
  v_sub_f32 v34, v34, v153
  v_sub_f32 v35, v35, v153
  v_sub_f32 v36, v36, v153
  v_sub_f32 v37, v37, v153
  v_sub_f32 v38, v38, v153
  v_sub_f32 v39, v39, v153
  v_exp_f32 v24, v24
  v_exp_f32 v25, v25
  v_exp_f32 v26, v26
  v_exp_f32 v27, v27
  v_exp_f32 v28, v28
  v_exp_f32 v29, v29
  v_exp_f32 v30, v30
  v_exp_f32 v31, v31
  v_exp_f32 v32, v32
  v_exp_f32 v33, v33
  v_exp_f32 v34, v34
  v_exp_f32 v35, v35
  v_exp_f32 v36, v36
  v_exp_f32 v37, v37
  v_exp_f32 v38, v38
  v_exp_f32 v39, v39
  s_nop 1
  v_smfmac_f32_32x32x32_bf16 v[88:103], v[132:135], v[24:31], v148
  v_smfmac_f32_32x32x32_bf16 v[88:103], v[140:143], v[32:39], v148
  v_sub_f32 v40, v40, v152
  v_sub_f32 v41, v41, v152
  v_sub_f32 v42, v42, v152
  v_sub_f32 v43, v43, v152
  v_sub_f32 v44, v44, v152
  v_sub_f32 v45, v45, v152
  v_sub_f32 v46, v46, v152
  v_sub_f32 v47, v47, v152
  v_sub_f32 v48, v48, v152
  v_sub_f32 v49, v49, v152
  v_sub_f32 v50, v50, v152
  v_sub_f32 v51, v51, v152
  v_sub_f32 v52, v52, v152
  v_sub_f32 v53, v53, v152
  v_sub_f32 v54, v54, v152
  v_sub_f32 v55, v55, v152
  v_exp_f32 v40, v40
  v_exp_f32 v41, v41
  v_exp_f32 v42, v42
  v_exp_f32 v43, v43
  v_exp_f32 v44, v44
  v_exp_f32 v45, v45
  v_exp_f32 v46, v46
  v_exp_f32 v47, v47
  v_exp_f32 v48, v48
  v_exp_f32 v49, v49
  v_exp_f32 v50, v50
  v_exp_f32 v51, v51
  v_exp_f32 v52, v52
  v_exp_f32 v53, v53
  v_exp_f32 v54, v54
  v_exp_f32 v55, v55
  s_nop 1
  v_smfmac_f32_32x32x32_bf16 v[72:87], v[136:139], v[40:47], v148
  v_smfmac_f32_32x32x32_bf16 v[72:87], v[144:147], v[48:55], v148
  v_sub_f32 v56, v56, v153
  v_sub_f32 v57, v57, v153
  v_sub_f32 v58, v58, v153
  v_sub_f32 v59, v59, v153
  v_sub_f32 v60, v60, v153
  v_sub_f32 v61, v61, v153
  v_sub_f32 v62, v62, v153
  v_sub_f32 v63, v63, v153
  v_sub_f32 v64, v64, v153
  v_sub_f32 v65, v65, v153
  v_sub_f32 v66, v66, v153
  v_sub_f32 v67, v67, v153
  v_sub_f32 v68, v68, v153
  v_sub_f32 v69, v69, v153
  v_sub_f32 v70, v70, v153
  v_sub_f32 v71, v71, v153
  v_exp_f32 v56, v56
  v_exp_f32 v57, v57
  v_exp_f32 v58, v58
  v_exp_f32 v59, v59
  v_exp_f32 v60, v60
  v_exp_f32 v61, v61
  v_exp_f32 v62, v62
  v_exp_f32 v63, v63
  v_exp_f32 v64, v64
  v_exp_f32 v65, v65
  v_exp_f32 v66, v66
  v_exp_f32 v67, v67
  v_exp_f32 v68, v68
  v_exp_f32 v69, v69
  v_exp_f32 v70, v70
  v_exp_f32 v71, v71
  s_nop 1
  v_smfmac_f32_32x32x32_bf16 v[88:103], v[136:139], v[56:63], v148
  v_smfmac_f32_32x32x32_bf16 v[88:103], v[144:147], v[64:71], v148
  v_add_u32 v158, 1024, v158
  v_add_u32 v159, 512, v159
  v_add_u32 v160, 2560, v160
  s_add_u32 s26, s26, 1
  s_cmp_lt_u32 s26, 16
  s_cbranch_scc1 k2_kernel_fb2
  s_nop 7
  s_nop 7
  s_branch k2_kernel_ok
k2_kernel_end:
  s_endpgm
code_end:
  s_endpgm
.section .rodata,"a"
.p2align 6
.amdhsa_kernel k1_kernel
  .amdhsa_next_free_vgpr 220
  .amdhsa_next_free_sgpr 102
  .amdhsa_accum_offset 220
  .amdhsa_group_segment_fixed_size 0
  .amdhsa_kernarg_size 80
  .amdhsa_user_sgpr_count 2
  .amdhsa_user_sgpr_kernarg_segment_ptr 1
  .amdhsa_system_sgpr_workgroup_id_x 1
  .amdhsa_float_denorm_mode_32 3
  .amdhsa_float_denorm_mode_16_64 3
.end_amdhsa_kernel
.p2align 6
.amdhsa_kernel k2_kernel
  .amdhsa_next_free_vgpr 244
  .amdhsa_next_free_sgpr 102
  .amdhsa_accum_offset 244
  .amdhsa_group_segment_fixed_size 0
  .amdhsa_kernarg_size 80
  .amdhsa_user_sgpr_count 2
  .amdhsa_user_sgpr_kernarg_segment_ptr 1
  .amdhsa_system_sgpr_workgroup_id_x 1
  .amdhsa_float_denorm_mode_32 3
  .amdhsa_float_denorm_mode_16_64 3
.end_amdhsa_kernel
```
